```python
import torch

def _softmax(x, axis=-1):
    return torch.softmax(x, dim=axis)

def _gelu(x):
    return torch.nn.functional.gelu(x, approximate='tanh')

def _silu(x):
    return torch.nn.functional.silu(x)

def _sigmoid(x):
    return torch.sigmoid(x)

def _layernorm(x, axis=-1, eps=1e-05):
    m = x.mean(dim=axis, keepdim=True)
    v = x.var(dim=axis, keepdim=True, unbiased=False)
    return (x - m) / torch.sqrt(v + eps)

def _scatter_add(tgt, idx, src, axis=0):
    return tgt.clone().index_add_(axis, idx, src)

def _segment_sum(src, seg, n):
    out = torch.zeros((n,) + src.shape[1:], dtype=src.dtype)
    return out.index_add_(0, seg, src)

def _pad(x, pw):
    flat = tuple((v for pair in reversed(pw) for v in pair))
    return torch.nn.functional.pad(x, flat)
kernel_name = 'standalone__factorization_afm__recsys'

def setup_inputs():

    _w = lambda a: (lambda t: t.to(torch.bfloat16) if t.is_floating_point() else t)(torch.as_tensor(a))
    B, F, D, V = (4096, 26, 64, min(1000, 100000))
    A = D
    ii, jj = tuple(torch.triu_indices(F, F, 1).unbind(0))
    return {'idx': _w((lambda lo, hi, *s: torch.randint(lo, hi, s))(0, V, B, F).to(torch.int64)), 'table': _w((lambda *s: torch.randn(*s, dtype=torch.bfloat16) * 1.6)(V, D)), 'ii': _w(ii.to(torch.int64)), 'jj': _w(jj.to(torch.int64)), 'W': _w((lambda *s: torch.randn(*s, dtype=torch.bfloat16) * 0.4)(D, A) * (1.0 / D ** 0.5)), 'b': _w((lambda *s: torch.randn(*s, dtype=torch.bfloat16) * 0.4)(A)), 'h': _w((lambda *s: torch.randn(*s, dtype=torch.bfloat16) * 0.4)(A)), 'p': _w((lambda *s: torch.randn(*s, dtype=torch.bfloat16) * 1.6)(D))}

def reference(idx, table, ii, jj, W, b, h, p):
    emb = table[idx]
    ei = emb[:, ii, :].clone()
    ej = emb[:, jj, :].clone()
    pair = ei * ej
    hid = pair @ W + b
    hid = 0.5 * (hid + torch.abs(hid))
    e = hid @ h
    alpha = _softmax(e, axis=-1)
    pooled = torch.einsum('bp,bpd->bd', alpha, pair)
    return pooled @ p
```

```asm
; @launch grid=(256,1,1) block=(512,1,1) lds=130496
.amdgcn_target "amdgcn-amd-amdhsa--gfx950"
.text
.globl standalone__factorization_afm__recsys_kernel
.p2align 8
.type standalone__factorization_afm__recsys_kernel,@function
standalone__factorization_afm__recsys_kernel:
    s_cmp_ge_u32 s2, 0x100
    s_cbranch_scc1 L_end
    s_load_dwordx2 s[24:25], s[0:1], 0
    s_load_dwordx2 s[32:33], s[0:1], 32
    s_load_dwordx2 s[28:29], s[0:1], 8
    s_load_dwordx2 s[36:37], s[0:1], 40
    s_load_dwordx2 s[40:41], s[0:1], 48
    s_load_dwordx2 s[44:45], s[0:1], 56
    s_load_dwordx2 s[48:49], s[0:1], 64
    s_getpc_b64 s[52:53]
L_pc:
    v_lshlrev_b32 v6, 7, v0
    v_min_u32 v6, L_alldone-L_pc-4, v6
    global_load_dword v242, v6, s[52:53]
    v_lshrrev_b32 v4, 6, v0
    v_and_b32 v5, 63, v0
    v_readfirstlane_b32 s56, v4
    v_lshlrev_b32 v0, 2, v5
    s_mul_i32 s57, s2, 1664
    s_mov_b32 s26, 425984
    s_mov_b32 s27, 0x20000
    s_mul_i32 s73, s56, 208
    s_add_u32 s57, s57, s73
    s_cmp_lt_u32 s56, 4
    s_cbranch_scc0 L_yng0
    s_waitcnt lgkmcnt(0)
    buffer_load_dword v237, v0, s[24:27], s57 offen
    s_setprio 3
    v_lshlrev_b32 v234, 4, v5
    s_mov_b32 s30, 128000
    s_mov_b32 s31, 0x20000
    s_mov_b32 s50, 8192
    s_mov_b32 s51, 0x20000
    s_cmp_eq_u32 s56, 3
    s_cbranch_scc0 L_o3
    s_lshr_b32 s59, s2, 3
    s_and_b32 s59, s59, 31
    s_lshl_b32 s59, s59, 12
    v_and_b32 v8, 31, v5
    v_lshlrev_b32 v14, 7, v8
L_o3:
    s_cmp_eq_u32 s56, 2
    s_cbranch_scc0 L_o2
    s_add_u32 s54, s52, L_tab-L_pc
    s_addc_u32 s55, s53, 0
    v_lshlrev_b32 v8, 3, v5
    global_load_dwordx2 v[228:229], v8, s[54:55]
L_o2:
    v_and_b32 v13, 15, v5
    v_cmp_le_u32 s[90:91], 32, v5
    v_cmp_gt_u32 s[92:93], 16, v5
    v_lshlrev_b32 v13, 3, v13
    v_mov_b32 v10, s40
    v_mov_b32 v11, s41
    v_mov_b32 v8, s44
    v_mov_b32 v9, s45
    v_cndmask_b32 v10, v10, v8, s[90:91]
    v_cndmask_b32 v11, v11, v9, s[90:91]
    v_mov_b32 v8, s36
    v_mov_b32 v9, s37
    v_cndmask_b32 v10, v10, v8, s[92:93]
    v_cndmask_b32 v11, v11, v9, s[92:93]
    v_add_co_u32 v10, vcc, v10, v13
    s_nop 1
    v_addc_co_u32 v11, vcc, 0, v11, vcc
    global_load_dwordx2 v[152:153], v[10:11], off
    v_and_b32 v12, 1, v5
    v_bfe_u32 v8, v5, 1, 1
    v_lshlrev_b32 v9, 4, v8
    v_lshl_or_b32 v9, v12, 3, v9
    v_bfe_u32 v8, v5, 3, 1
    v_lshl_or_b32 v9, v8, 2, v9
    v_bfe_u32 v8, v5, 2, 1
    v_lshl_or_b32 v9, v8, 1, v9
    v_lshlrev_b32 v9, 2, v9
    v_add_u32 v9, 129536, v9
    v_add_u32 v10, 129664, v13
    v_add_u32 v8, 129792, v13
    v_cndmask_b32 v9, v9, v10, s[90:91]
    v_cndmask_b32 v7, v9, v8, s[92:93]
    s_branch L_j0
L_yng0:
    v_lshlrev_b32 v234, 4, v5
    s_mov_b32 s34, 8192
    s_mov_b32 s35, 0x20000
    s_sub_u32 s72, s56, 4
    s_lshl_b32 s58, s72, 11
    s_waitcnt lgkmcnt(0)
    buffer_load_dwordx4 v[144:147], v234, s[32:35], s58 offen
    buffer_load_dwordx4 v[148:151], v234, s[32:35], s58 offen offset:1024
    buffer_load_dword v237, v0, s[24:27], s57 offen
    s_setprio 3
    s_mul_i32 s94, s72, 4736
    s_add_u32 s94, s94, 110592
    s_mov_b32 s30, 128000
    s_mov_b32 s31, 0x20000
    s_mov_b32 s50, 8192
    s_mov_b32 s51, 0x20000
L_j0:
    s_mov_b32 s70, 0x7fff7fff
    s_mov_b32 s71, 0x80008000
    s_mov_b32 s38, 0xffff0000
    v_lshrrev_b32 v232, 3, v5
    v_and_b32 v233, 7, v5
    v_mul_u32_u24 v235, 144, v232
    v_lshlrev_b32 v233, 4, v233
    v_mul_u32_u24 v226, 288, v232
    s_mul_i32 s82, s56, 13824
    v_add3_u32 v235, v235, v233, s82
    v_cmp_le_u32 vcc, 16, v5
    v_add_u32 v226, v226, v233
    v_lshlrev_b32 v232, 2, v232
    v_add_u32 v236, 4320, v235
    v_cndmask_b32 v236, v235, v236, vcc
    s_mov_b32 s95, 110592
    s_cmp_lt_u32 s56, 4
    s_cbranch_scc1 L_old2
    s_waitcnt vmcnt(1)
    s_lshl_b32 s76, s56, 2
    v_add_u32 v12, s94, v226
    s_add_u32 s76, s76, 129904
    v_pk_maximum3_f16 v154, v144, v144, v144 neg_lo:[0,1,0] neg_hi:[0,1,0]
    v_pk_maximum3_f16 v154, v145, v145, v154 neg_lo:[0,1,0] neg_hi:[0,1,0]
    v_pk_maximum3_f16 v154, v146, v146, v154 neg_lo:[0,1,0] neg_hi:[0,1,0]
    v_pk_maximum3_f16 v154, v147, v147, v154 neg_lo:[0,1,0] neg_hi:[0,1,0]
    v_pk_maximum3_f16 v154, v148, v148, v154 neg_lo:[0,1,0] neg_hi:[0,1,0]
    v_pk_maximum3_f16 v154, v149, v149, v154 neg_lo:[0,1,0] neg_hi:[0,1,0]
    v_pk_maximum3_f16 v154, v150, v150, v154 neg_lo:[0,1,0] neg_hi:[0,1,0]
    v_pk_maximum3_f16 v154, v151, v151, v154 neg_lo:[0,1,0] neg_hi:[0,1,0]
    v_mov_b32 v9, s76
    v_max_u32_sdwa v154, v154, v154 dst_sel:DWORD dst_unused:UNUSED_PAD src0_sel:WORD_0 src1_sel:WORD_1
    s_mov_b32 s36, 0x3d000000
    s_mov_b32 s37, 0x3d000000
    v_lshlrev_b32 v10, 16, v144
    v_and_b32 v11, s38, v144
    v_pk_mul_f32 v[10:11], v[10:11], s[36:37]
    v_cvt_pk_f16_f32 v96, v10, v11
    v_max_u32_dpp v154, v154, v154 row_ror:8 row_mask:0xf bank_mask:0xf
    v_lshlrev_b32 v10, 16, v145
    v_and_b32 v11, s38, v145
    v_pk_mul_f32 v[10:11], v[10:11], s[36:37]
    v_cvt_pk_f16_f32 v97, v10, v11
    v_max_u32_dpp v154, v154, v154 row_ror:4 row_mask:0xf bank_mask:0xf
    v_lshlrev_b32 v10, 16, v146
    v_and_b32 v11, s38, v146
    v_pk_mul_f32 v[10:11], v[10:11], s[36:37]
    v_cvt_pk_f16_f32 v98, v10, v11
    v_max_u32_dpp v154, v154, v154 row_ror:2 row_mask:0xf bank_mask:0xf
    v_lshlrev_b32 v10, 16, v147
    v_and_b32 v11, s38, v147
    v_pk_mul_f32 v[10:11], v[10:11], s[36:37]
    v_cvt_pk_f16_f32 v99, v10, v11
    v_max_u32_dpp v154, v154, v154 row_ror:1 row_mask:0xf bank_mask:0xf
    ds_write_b128 v12, v[96:99]
    v_lshlrev_b32 v10, 16, v148
    v_and_b32 v11, s38, v148
    v_pk_mul_f32 v[10:11], v[10:11], s[36:37]
    v_cvt_pk_f16_f32 v100, v10, v11
    v_max_u32_dpp v154, v154, v154 row_bcast:15 row_mask:0xa bank_mask:0xf
    v_lshlrev_b32 v10, 16, v149
    v_and_b32 v11, s38, v149
    v_pk_mul_f32 v[10:11], v[10:11], s[36:37]
    v_cvt_pk_f16_f32 v101, v10, v11
    v_max_u32_dpp v154, v154, v154 row_bcast:31 row_mask:0xc bank_mask:0xf
    v_lshlrev_b32 v10, 16, v150
    v_and_b32 v11, s38, v150
    v_pk_mul_f32 v[10:11], v[10:11], s[36:37]
    v_cvt_pk_f16_f32 v102, v10, v11
    v_lshlrev_b32 v10, 16, v151
    v_and_b32 v11, s38, v151
    v_pk_mul_f32 v[10:11], v[10:11], s[36:37]
    v_cvt_pk_f16_f32 v103, v10, v11
    ds_write_b128 v12, v[100:103] offset:2304
    s_mov_b32 exec_lo, 0
    s_mov_b32 exec_hi, 0x80000000
    ds_write_b32 v9, v154
    s_mov_b64 exec, -1
    s_waitcnt lgkmcnt(0)
    s_barrier
    s_setprio 2
    s_waitcnt vmcnt(0)
    ds_bpermute_b32 v128, v232, v237 offset:0
    ds_bpermute_b32 v129, v232, v237 offset:32
    ds_bpermute_b32 v130, v232, v237 offset:64
    ds_bpermute_b32 v131, v232, v237 offset:96
    ds_bpermute_b32 v132, v232, v237 offset:128
    ds_bpermute_b32 v133, v232, v237 offset:160
    ds_bpermute_b32 v134, v232, v237 offset:192
    s_waitcnt lgkmcnt(6)
    v_lshl_add_u32 v128, v128, 7, v233
    buffer_load_dwordx4 v[196:199], v128, s[28:31], 0 offen
    s_waitcnt lgkmcnt(5)
    v_lshl_add_u32 v129, v129, 7, v233
    buffer_load_dwordx4 v[200:203], v129, s[28:31], 0 offen
    s_waitcnt lgkmcnt(4)
    v_lshl_add_u32 v130, v130, 7, v233
    buffer_load_dwordx4 v[212:215], v130, s[28:31], 0 offen
    s_waitcnt lgkmcnt(3)
    v_lshl_add_u32 v131, v131, 7, v233
    buffer_load_dwordx4 v[204:207], v131, s[28:31], 0 offen
    s_waitcnt lgkmcnt(2)
    v_lshl_add_u32 v132, v132, 7, v233
    buffer_load_dwordx4 v[208:211], v132, s[28:31], 0 offen
    s_waitcnt lgkmcnt(1)
    v_lshl_add_u32 v133, v133, 7, v233
    buffer_load_dwordx4 v[216:219], v133, s[28:31], 0 offen
    s_waitcnt lgkmcnt(0)
    v_lshl_add_u32 v134, v134, 7, v233
    buffer_load_dwordx4 v[220:223], v134, s[28:31], 0 offen
    v_and_b32 v8, 3, v5
    v_bfe_u32 v9, v5, 2, 1
    v_bfe_u32 v10, v5, 3, 1
    v_xor_b32 v9, v9, v10
    v_mul_u32_u24 v10, 56, v10
    v_xor_b32 v9, 1, v9
    v_lshl_add_u32 v8, v8, 1, v9
    v_lshrrev_b32 v11, 4, v5
    v_add_u32 v8, v8, v10
    v_mul_u32_u24 v8, 144, v8
    v_and_b32 v12, 1, v5
    v_lshl_add_u32 v8, v11, 5, v8
    v_mov_b32 v2, 0x4444
    v_mov_b32 v9, 0xeeee
    v_cmp_eq_u32 vcc, 1, v12
    v_add_u32 v1, s82, v8
    v_bfe_u32 v8, v5, 2, 2
    v_cndmask_b32 v2, v2, v9, vcc
    v_mul_u32_u24 v8, 288, v8
    v_mul_u32_u24 v10, 4736, v11
    v_and_b32 v9, 3, v5
    v_lshl_add_u32 v8, v9, 3, v8
    v_add3_u32 v3, v8, v10, s95
    v_and_b32 v8, 1, v11
    v_lshrrev_b32 v9, 1, v11
    v_lshl_add_u32 v8, v8, 4, v12
    v_lshl_add_u32 v8, v9, 2, v8
    v_bfe_u32 v9, v5, 1, 1
    v_lshl_add_u32 v8, v9, 5, v8
    v_lshlrev_b32 v8, 2, v8
    v_add_u32 v4, 129536, v8
    v_and_b32 v13, 15, v5
    v_lshlrev_b32 v8, 1, v13
    v_add_u32 v6, 129792, v8
    v_mov_b32 v65, 0
    v_mov_b64 v[66:67], 0
    v_mov_b32 v69, 0
    v_mov_b64 v[70:71], 0
    v_mov_b32 v73, 0
    v_mov_b64 v[74:75], 0
    v_mov_b32 v77, 0
    v_mov_b64 v[78:79], 0
    v_mov_b32 v81, 0
    v_mov_b64 v[82:83], 0
    s_mov_b32 s4, 196611
    s_mov_b32 s5, 196611
    s_mov_b32 s12, 786444
    s_mov_b32 s13, 786444
    s_mov_b32 s6, 3145776
    s_mov_b32 s7, 3145776
    s_mov_b32 s14, 12583104
    s_mov_b32 s15, 12583104
    s_mov_b32 s8, 50332416
    s_mov_b32 s9, 50332416
    s_mov_b32 s16, 201329664
    s_mov_b32 s17, 201329664
    s_mov_b32 s10, 805318656
    s_mov_b32 s11, 805318656
    s_mov_b32 s18, 3221274624
    s_mov_b32 s19, 3221274624
    v_mov_b32 v8, 129920
    ds_read_b128 v[156:159], v8
    ds_read_b64 v[152:153], v8 offset:16
    ds_read_u16 v64, v6 offset:0
    ds_read_u16 v68, v6 offset:32
    ds_read_u16 v72, v6 offset:64
    ds_read_u16 v76, v6 offset:96
    ds_read_b64_tr_b16 v[16:17], v3 offset:0
    ds_read_b64_tr_b16 v[18:19], v3 offset:1152
    ds_read_b64_tr_b16 v[20:21], v3 offset:2304
    ds_read_b64_tr_b16 v[22:23], v3 offset:3456
    ds_read_b64_tr_b16 v[24:25], v3 offset:32
    ds_read_b64_tr_b16 v[26:27], v3 offset:1184
    ds_read_b64_tr_b16 v[28:29], v3 offset:2336
    ds_read_b64_tr_b16 v[30:31], v3 offset:3488
    ds_read_b64_tr_b16 v[32:33], v3 offset:64
    ds_read_b64_tr_b16 v[34:35], v3 offset:1216
    ds_read_b64_tr_b16 v[36:37], v3 offset:2368
    ds_read_b64_tr_b16 v[38:39], v3 offset:3520
    ds_read_b64_tr_b16 v[40:41], v3 offset:96
    ds_read_b64_tr_b16 v[42:43], v3 offset:1248
    ds_read_b64_tr_b16 v[44:45], v3 offset:2400
    ds_read_b64_tr_b16 v[46:47], v3 offset:3552
    s_branch L_j2
L_old2:
    v_and_b32 v8, 3, v5
    v_bfe_u32 v9, v5, 2, 1
    v_bfe_u32 v10, v5, 3, 1
    v_xor_b32 v9, v9, v10
    v_mul_u32_u24 v10, 56, v10
    v_xor_b32 v9, 1, v9
    v_lshl_add_u32 v8, v8, 1, v9
    v_lshrrev_b32 v11, 4, v5
    v_add_u32 v8, v8, v10
    v_mul_u32_u24 v8, 144, v8
    v_and_b32 v12, 1, v5
    v_lshl_add_u32 v8, v11, 5, v8
    v_mov_b32 v2, 0x4444
    v_mov_b32 v9, 0xeeee
    v_cmp_eq_u32 vcc, 1, v12
    v_add_u32 v1, s82, v8
    v_bfe_u32 v8, v5, 2, 2
    v_cndmask_b32 v2, v2, v9, vcc
    v_mul_u32_u24 v8, 288, v8
    v_mul_u32_u24 v10, 4736, v11
    v_and_b32 v9, 3, v5
    v_lshl_add_u32 v8, v9, 3, v8
    v_add3_u32 v3, v8, v10, s95
    v_and_b32 v8, 1, v11
    v_lshrrev_b32 v9, 1, v11
    v_lshl_add_u32 v8, v8, 4, v12
    v_lshl_add_u32 v8, v9, 2, v8
    v_bfe_u32 v9, v5, 1, 1
    v_lshl_add_u32 v8, v9, 5, v8
    v_lshlrev_b32 v8, 2, v8
    v_add_u32 v4, 129536, v8
    v_and_b32 v13, 15, v5
    v_lshlrev_b32 v8, 1, v13
    v_add_u32 v6, 129792, v8
    v_mov_b32 v65, 0
    v_mov_b64 v[66:67], 0
    v_mov_b32 v69, 0
    v_mov_b64 v[70:71], 0
    v_mov_b32 v73, 0
    v_mov_b64 v[74:75], 0
    v_mov_b32 v77, 0
    v_mov_b64 v[78:79], 0
    v_mov_b32 v81, 0
    v_mov_b64 v[82:83], 0
    s_mov_b32 s4, 196611
    s_mov_b32 s5, 196611
    s_mov_b32 s12, 786444
    s_mov_b32 s13, 786444
    s_mov_b32 s6, 3145776
    s_mov_b32 s7, 3145776
    s_mov_b32 s14, 12583104
    s_mov_b32 s15, 12583104
    s_mov_b32 s8, 50332416
    s_mov_b32 s9, 50332416
    s_mov_b32 s16, 201329664
    s_mov_b32 s17, 201329664
    s_mov_b32 s10, 805318656
    s_mov_b32 s11, 805318656
    s_mov_b32 s18, 3221274624
    s_mov_b32 s19, 3221274624
    s_waitcnt vmcnt(1)
    ds_bpermute_b32 v128, v232, v237 offset:0
    ds_bpermute_b32 v129, v232, v237 offset:32
    ds_bpermute_b32 v130, v232, v237 offset:64
    ds_bpermute_b32 v131, v232, v237 offset:96
    ds_bpermute_b32 v132, v232, v237 offset:128
    ds_bpermute_b32 v133, v232, v237 offset:160
    ds_bpermute_b32 v134, v232, v237 offset:192
    s_waitcnt lgkmcnt(6)
    v_lshl_add_u32 v128, v128, 7, v233
    buffer_load_dwordx4 v[196:199], v128, s[28:31], 0 offen
    s_waitcnt lgkmcnt(5)
    v_lshl_add_u32 v129, v129, 7, v233
    buffer_load_dwordx4 v[200:203], v129, s[28:31], 0 offen
    s_waitcnt lgkmcnt(4)
    v_lshl_add_u32 v130, v130, 7, v233
    buffer_load_dwordx4 v[212:215], v130, s[28:31], 0 offen
    s_waitcnt lgkmcnt(3)
    v_lshl_add_u32 v131, v131, 7, v233
    buffer_load_dwordx4 v[204:207], v131, s[28:31], 0 offen
    s_waitcnt lgkmcnt(2)
    v_lshl_add_u32 v132, v132, 7, v233
    buffer_load_dwordx4 v[208:211], v132, s[28:31], 0 offen
    s_waitcnt lgkmcnt(1)
    v_lshl_add_u32 v133, v133, 7, v233
    buffer_load_dwordx4 v[216:219], v133, s[28:31], 0 offen
    s_waitcnt lgkmcnt(0)
    v_lshl_add_u32 v134, v134, 7, v233
    buffer_load_dwordx4 v[220:223], v134, s[28:31], 0 offen
    s_waitcnt vmcnt(7)
    v_pk_maximum3_f16 v155, v152, v152, v152 neg_lo:[0,1,0] neg_hi:[0,1,0]
    v_pk_maximum3_f16 v155, v153, v153, v155 neg_lo:[0,1,0] neg_hi:[0,1,0]
    v_mov_b32 v10, 129936
    v_max_u32_sdwa v155, v155, v155 dst_sel:DWORD dst_unused:UNUSED_PAD src0_sel:WORD_0 src1_sel:WORD_1
    s_nop 1
    v_max_u32_dpp v155, v155, v155 row_ror:8 row_mask:0xf bank_mask:0xf
    s_nop 1
    v_max_u32_dpp v155, v155, v155 row_ror:4 row_mask:0xf bank_mask:0xf
    s_nop 1
    v_max_u32_dpp v155, v155, v155 row_ror:2 row_mask:0xf bank_mask:0xf
    s_nop 1
    v_max_u32_dpp v155, v155, v155 row_ror:1 row_mask:0xf bank_mask:0xf
    s_nop 0
    v_readlane_b32 s61, v155, 0
    v_readlane_b32 s62, v155, 32
    s_nop 0
    v_mov_b32 v8, s61
    v_mov_b32 v9, s62
    s_nop 0
    s_lshr_b32 s72, s62, 7
    s_max_u32 s72, s72, 40
    ds_write_b64 v10, v[8:9]
    s_sub_u32 s72, s72, 29
    s_lshl_b32 s72, s72, 7
    s_mul_i32 s68, s72, 0x10001
    v_and_b32 v11, s70, v152
    v_pk_sub_u16 v11, v11, s68 clamp
    v_lshlrev_b32 v11, 3, v11
    v_and_or_b32 v12, v152, s71, v11
    v_and_b32 v10, s70, v153
    v_pk_sub_u16 v10, v10, s68 clamp
    v_lshlrev_b32 v10, 3, v10
    v_and_or_b32 v13, v153, s71, v10
    v_cndmask_b32 v152, v152, v12, s[90:91]
    v_cndmask_b32 v153, v153, v13, s[90:91]
    ds_write_b64 v7, v[152:153]
    s_cmp_eq_u32 s56, 2
    s_cbranch_scc0 L_t3
    v_lshlrev_b32 v8, 3, v5
    v_add_u32 v8, 129984, v8
    ds_write_b64 v8, v[228:229]
L_t3:
    s_waitcnt lgkmcnt(0)
    s_barrier
    v_mov_b32 v8, 129920
    ds_read_b128 v[156:159], v8
    ds_read_b64 v[152:153], v8 offset:16
    ds_read_u16 v64, v6 offset:0
    ds_read_u16 v68, v6 offset:32
    ds_read_u16 v72, v6 offset:64
    ds_read_u16 v76, v6 offset:96
    ds_read_b64_tr_b16 v[16:17], v3 offset:0
    ds_read_b64_tr_b16 v[18:19], v3 offset:1152
    ds_read_b64_tr_b16 v[20:21], v3 offset:2304
    ds_read_b64_tr_b16 v[22:23], v3 offset:3456
    ds_read_b64_tr_b16 v[24:25], v3 offset:32
    ds_read_b64_tr_b16 v[26:27], v3 offset:1184
    ds_read_b64_tr_b16 v[28:29], v3 offset:2336
    ds_read_b64_tr_b16 v[30:31], v3 offset:3488
    ds_read_b64_tr_b16 v[32:33], v3 offset:64
    ds_read_b64_tr_b16 v[34:35], v3 offset:1216
    ds_read_b64_tr_b16 v[36:37], v3 offset:2368
    ds_read_b64_tr_b16 v[38:39], v3 offset:3520
    ds_read_b64_tr_b16 v[40:41], v3 offset:96
    ds_read_b64_tr_b16 v[42:43], v3 offset:1248
    ds_read_b64_tr_b16 v[44:45], v3 offset:2400
    ds_read_b64_tr_b16 v[46:47], v3 offset:3552
L_j2:
    s_waitcnt lgkmcnt(15)
    v_max3_u32 v156, v156, v157, v158
    v_readfirstlane_b32 s61, v152
    v_readfirstlane_b32 s62, v153
    v_max_u32 v156, v156, v159
    s_mov_b32 s39, 5
    s_movk_i32 s43, 111
    v_readfirstlane_b32 s60, v156
    s_mov_b32 s46, 0
    s_mov_b32 s47, 0
    s_lshr_b32 s61, s61, 7
    v_cmp_gt_u32 vcc, 16, v5
    s_lshr_b32 s60, s60, 7
    s_sub_u32 s72, s60, 120
    s_cmp_gt_u32 s72, 10
    s_cbranch_scc1 L_slowW
L_slowW_back:
L_rebook:
    s_sub_i32 s64, s43, s60
    s_add_i32 s66, s61, s64
    s_add_i32 s36, s64, s39
    s_addk_i32 s66, -125
    s_add_i32 s37, s36, s46
    s_max_i32 s66, s66, 0
    s_sub_i32 s64, s64, s66
    s_add_i32 s83, s64, 127
    s_max_i32 s83, s83, 0
    s_lshl_b32 s83, s83, 7
    v_mov_b32 v7, s83
    s_cmp_gt_i32 s66, 0
    s_cbranch_scc1 L_rare
L_rare_back:
    v_cndmask_b32 v80, 0, v7, vcc
    s_add_i32 s72, s37, 15
    s_lshl_b32 s72, s72, 10
    v_mfma_f32_16x16x32_bf16 v[48:51], v[64:67], v[80:83], 0
    v_mfma_f32_16x16x32_bf16 v[52:55], v[68:71], v[80:83], 0
    v_mfma_f32_16x16x32_bf16 v[56:59], v[72:75], v[80:83], 0
    v_mfma_f32_16x16x32_bf16 v[60:63], v[76:79], v[80:83], 0
    s_mul_i32 s42, s72, 0x10001
    s_waitcnt vmcnt(6)
    v_lshlrev_b32 v8, 16, v196
    v_and_b32 v9, s38, v196
    v_cvt_pk_f16_f32 v196, v8, v9
    v_lshlrev_b32 v10, 16, v197
    v_and_b32 v11, s38, v197
    v_cvt_pk_f16_f32 v197, v10, v11
    v_lshlrev_b32 v8, 16, v198
    v_and_b32 v9, s38, v198
    v_cvt_pk_f16_f32 v198, v8, v9
    v_lshlrev_b32 v10, 16, v199
    v_and_b32 v11, s38, v199
    v_cvt_pk_f16_f32 v199, v10, v11
    ds_write_b128 v235, v[196:199] offset:0
    s_waitcnt vmcnt(5)
    v_lshlrev_b32 v8, 16, v200
    v_and_b32 v9, s38, v200
    v_cvt_pk_f16_f32 v200, v8, v9
    v_lshlrev_b32 v10, 16, v201
    v_and_b32 v11, s38, v201
    v_cvt_pk_f16_f32 v201, v10, v11
    v_lshlrev_b32 v8, 16, v202
    v_and_b32 v9, s38, v202
    v_cvt_pk_f16_f32 v202, v8, v9
    v_lshlrev_b32 v10, 16, v203
    v_and_b32 v11, s38, v203
    v_cvt_pk_f16_f32 v203, v10, v11
    ds_write_b128 v235, v[200:203] offset:1152
    s_waitcnt vmcnt(3)
    v_lshlrev_b32 v8, 16, v204
    v_and_b32 v9, s38, v204
    v_cvt_pk_f16_f32 v204, v8, v9
    v_lshlrev_b32 v10, 16, v205
    v_and_b32 v11, s38, v205
    v_cvt_pk_f16_f32 v205, v10, v11
    v_lshlrev_b32 v8, 16, v206
    v_and_b32 v9, s38, v206
    v_cvt_pk_f16_f32 v206, v8, v9
    v_lshlrev_b32 v10, 16, v207
    v_and_b32 v11, s38, v207
    v_cvt_pk_f16_f32 v207, v10, v11
    ds_write_b128 v236, v[204:207] offset:3456
    s_waitcnt vmcnt(2)
    v_lshlrev_b32 v8, 16, v208
    v_and_b32 v9, s38, v208
    v_cvt_pk_f16_f32 v208, v8, v9
    v_lshlrev_b32 v10, 16, v209
    v_and_b32 v11, s38, v209
    v_cvt_pk_f16_f32 v209, v10, v11
    v_lshlrev_b32 v8, 16, v210
    v_and_b32 v9, s38, v210
    v_cvt_pk_f16_f32 v210, v8, v9
    v_lshlrev_b32 v10, 16, v211
    v_and_b32 v11, s38, v211
    v_cvt_pk_f16_f32 v211, v10, v11
    ds_write_b128 v235, v[208:211] offset:8928
    ds_read_b128 v[96:99], v1 offset:0
    ds_read_b128 v[100:103], v1 offset:16
    ds_read_b128 v[104:107], v1 offset:144
    ds_read_b128 v[108:111], v1 offset:160
    ds_read_b128 v[112:115], v1 offset:288
    ds_read_b128 v[116:119], v1 offset:304
    v_mov_b64 v[8:9], 0
    v_mov_b64 v[10:11], 0
    s_waitcnt lgkmcnt(2)
    v_pk_mul_f16 v96, v96, s42
    v_pk_mul_f16 v97, v97, s42
    v_pk_mul_f16 v98, v98, s42
    v_pk_mul_f16 v99, v99, s42
    v_pk_mul_f16 v100, v100, s42
    v_pk_mul_f16 v101, v101, s42
    v_pk_mul_f16 v102, v102, s42
    v_pk_mul_f16 v103, v103, s42
    v_pk_mul_f16 v128, v96, v104
    v_pk_mul_f16 v129, v97, v105
    v_pk_mul_f16 v130, v98, v106
    v_pk_mul_f16 v131, v99, v107
    v_pk_mul_f16 v132, v100, v108
    v_pk_mul_f16 v133, v101, v109
    v_pk_mul_f16 v134, v102, v110
    v_pk_mul_f16 v135, v103, v111
    s_waitcnt vmcnt(1)
    v_lshlrev_b32 v225, 3, v5
    v_add_u32 v225, 129984, v225
    ds_read2_b32 v[238:239], v4 offset0:0 offset1:2
    ds_read2_b32 v[240:241], v4 offset0:8 offset1:10
    ds_read_b64 v[228:229], v225
    s_setprio 2
    v_mfma_f32_16x16x32_f16 v[64:67], v[16:19], v[128:131], v[48:51]
    v_lshlrev_b32 v230, 16, v216
    v_and_b32 v231, s38, v216
    v_cvt_pk_f16_f32 v216, v230, v231
    v_mfma_f32_16x16x32_f16 v[64:67], v[20:23], v[132:135], v[64:67]
    v_lshlrev_b32 v230, 16, v217
    v_and_b32 v231, s38, v217
    v_cvt_pk_f16_f32 v217, v230, v231
    v_mfma_f32_16x16x32_f16 v[68:71], v[24:27], v[128:131], v[52:55]
    v_lshlrev_b32 v230, 16, v218
    v_and_b32 v231, s38, v218
    v_cvt_pk_f16_f32 v218, v230, v231
    v_mfma_f32_16x16x32_f16 v[68:71], v[28:31], v[132:135], v[68:71]
    v_lshlrev_b32 v230, 16, v219
    v_and_b32 v231, s38, v219
    v_cvt_pk_f16_f32 v219, v230, v231
    v_pk_maximum3_f16 v224, v196, v196, v196 neg_lo:[0,1,0] neg_hi:[0,1,0]
    v_pk_maximum3_f16 v224, v197, v197, v224 neg_lo:[0,1,0] neg_hi:[0,1,0]
    v_pk_maximum3_f16 v224, v198, v198, v224 neg_lo:[0,1,0] neg_hi:[0,1,0]
    v_pk_maximum3_f16 v224, v199, v199, v224 neg_lo:[0,1,0] neg_hi:[0,1,0]
    v_pk_maximum3_f16 v224, v200, v200, v224 neg_lo:[0,1,0] neg_hi:[0,1,0]
    v_pk_maximum3_f16 v224, v201, v201, v224 neg_lo:[0,1,0] neg_hi:[0,1,0]
    v_pk_maximum3_f16 v224, v202, v202, v224 neg_lo:[0,1,0] neg_hi:[0,1,0]
    v_pk_maximum3_f16 v224, v203, v203, v224 neg_lo:[0,1,0] neg_hi:[0,1,0]
    ds_write_b128 v235, v[216:219] offset:10080
    s_waitcnt lgkmcnt(1)
    v_cndmask_b32 v176, 0, v238, s[12:13]
    v_cndmask_b32 v177, 0, v239, s[12:13]
    v_cndmask_b32 v178, 0, v240, s[12:13]
    v_cndmask_b32 v179, 0, v241, s[12:13]
    v_cndmask_b32 v160, 0, v238, s[4:5]
    v_cndmask_b32 v161, 0, v239, s[4:5]
    v_cndmask_b32 v162, 0, v240, s[4:5]
    v_cndmask_b32 v163, 0, v241, s[4:5]
    v_smfmac_f32_16x16x64_f16 v[8:11], v[176:179], v[128:135], v2
    ds_read_b128 v[104:107], v1 offset:432
    ds_read_b128 v[108:111], v1 offset:448
    v_mfma_f32_16x16x32_f16 v[72:75], v[32:35], v[128:131], v[56:59]
    v_pk_mul_f16 v136, v96, v112
    v_pk_mul_f16 v137, v97, v113
    v_mfma_f32_16x16x32_f16 v[72:75], v[36:39], v[132:135], v[72:75]
    v_pk_mul_f16 v138, v98, v114
    v_pk_mul_f16 v139, v99, v115
    v_mfma_f32_16x16x32_f16 v[76:79], v[40:43], v[128:131], v[60:63]
    v_pk_mul_f16 v140, v100, v116
    v_pk_mul_f16 v141, v101, v117
    v_mfma_f32_16x16x32_f16 v[76:79], v[44:47], v[132:135], v[76:79]
    v_pk_mul_f16 v142, v102, v118
    v_pk_mul_f16 v143, v103, v119
    v_cndmask_b32 v180, 0, v238, s[14:15]
    v_cndmask_b32 v181, 0, v239, s[14:15]
    v_cndmask_b32 v182, 0, v240, s[14:15]
    v_cndmask_b32 v183, 0, v241, s[14:15]
    v_cndmask_b32 v164, 0, v238, s[6:7]
    v_cndmask_b32 v165, 0, v239, s[6:7]
    v_cndmask_b32 v166, 0, v240, s[6:7]
    v_cndmask_b32 v167, 0, v241, s[6:7]
    s_waitcnt vmcnt(0)
    v_mfma_f32_16x16x32_f16 v[80:83], v[16:19], v[136:139], v[48:51]
    v_cvt_pk_bf16_f32 v144, v64, v65 clamp
    v_cvt_pk_bf16_f32 v145, v66, v67 clamp
    v_lshlrev_b32 v230, 16, v220
    v_and_b32 v231, s38, v220
    v_cvt_pk_f16_f32 v220, v230, v231
    v_mfma_f32_16x16x32_f16 v[80:83], v[20:23], v[140:143], v[80:83]
    v_cvt_pk_bf16_f32 v146, v68, v69 clamp
    v_cvt_pk_bf16_f32 v147, v70, v71 clamp
    v_lshlrev_b32 v230, 16, v221
    v_and_b32 v231, s38, v221
    v_cvt_pk_f16_f32 v221, v230, v231
    v_mfma_f32_16x16x32_f16 v[84:87], v[24:27], v[136:139], v[52:55]
    v_cvt_pk_bf16_f32 v148, v72, v73 clamp
    v_cvt_pk_bf16_f32 v149, v74, v75 clamp
    v_lshlrev_b32 v230, 16, v222
    v_and_b32 v231, s38, v222
    v_cvt_pk_f16_f32 v222, v230, v231
    v_mfma_f32_16x16x32_f16 v[84:87], v[28:31], v[140:143], v[84:87]
    v_cvt_pk_bf16_f32 v150, v76, v77 clamp
    v_cvt_pk_bf16_f32 v151, v78, v79 clamp
    v_lshlrev_b32 v230, 16, v223
    v_and_b32 v231, s38, v223
    v_cvt_pk_f16_f32 v223, v230, v231
    v_pk_maximum3_f16 v224, v204, v204, v224 neg_lo:[0,1,0] neg_hi:[0,1,0]
    v_pk_maximum3_f16 v224, v205, v205, v224 neg_lo:[0,1,0] neg_hi:[0,1,0]
    v_pk_maximum3_f16 v224, v206, v206, v224 neg_lo:[0,1,0] neg_hi:[0,1,0]
    v_pk_maximum3_f16 v224, v207, v207, v224 neg_lo:[0,1,0] neg_hi:[0,1,0]
    v_pk_maximum3_f16 v224, v208, v208, v224 neg_lo:[0,1,0] neg_hi:[0,1,0]
    v_pk_maximum3_f16 v224, v209, v209, v224 neg_lo:[0,1,0] neg_hi:[0,1,0]
    v_pk_maximum3_f16 v224, v210, v210, v224 neg_lo:[0,1,0] neg_hi:[0,1,0]
    v_pk_maximum3_f16 v224, v211, v211, v224 neg_lo:[0,1,0] neg_hi:[0,1,0]
    v_pk_maximum3_f16 v224, v216, v216, v224 neg_lo:[0,1,0] neg_hi:[0,1,0]
    v_pk_maximum3_f16 v224, v217, v217, v224 neg_lo:[0,1,0] neg_hi:[0,1,0]
    v_pk_maximum3_f16 v224, v218, v218, v224 neg_lo:[0,1,0] neg_hi:[0,1,0]
    v_pk_maximum3_f16 v224, v219, v219, v224 neg_lo:[0,1,0] neg_hi:[0,1,0]
    s_mov_b32 exec_hi, 0
    ds_write_b128 v235, v[220:223] offset:11232
    s_mov_b32 exec_hi, -1
    v_smfmac_f32_16x16x64_f16 v[8:11], v[180:183], v[136:143], v2
    ds_read_b128 v[112:115], v1 offset:576
    ds_read_b128 v[116:119], v1 offset:592
    v_mfma_f32_16x16x32_f16 v[88:91], v[32:35], v[136:139], v[56:59]
    s_waitcnt lgkmcnt(3)
    v_pk_mul_f16 v128, v96, v104
    v_pk_mul_f16 v129, v97, v105
    v_mfma_f32_16x16x32_f16 v[88:91], v[36:39], v[140:143], v[88:91]
    v_pk_mul_f16 v130, v98, v106
    v_pk_mul_f16 v131, v99, v107
    v_mfma_f32_16x16x32_f16 v[92:95], v[40:43], v[136:139], v[60:63]
    v_pk_mul_f16 v132, v100, v108
    v_pk_mul_f16 v133, v101, v109
    v_mfma_f32_16x16x32_f16 v[92:95], v[44:47], v[140:143], v[92:95]
    v_pk_mul_f16 v134, v102, v110
    v_pk_mul_f16 v135, v103, v111
    v_smfmac_f32_16x16x64_bf16 v[8:11], v[160:163], v[144:151], v2
    v_cndmask_b32 v184, 0, v238, s[16:17]
    v_cndmask_b32 v185, 0, v239, s[16:17]
    v_cndmask_b32 v186, 0, v240, s[16:17]
    v_cndmask_b32 v187, 0, v241, s[16:17]
    v_cndmask_b32 v168, 0, v238, s[8:9]
    v_cndmask_b32 v169, 0, v239, s[8:9]
    v_cndmask_b32 v170, 0, v240, s[8:9]
    v_cndmask_b32 v171, 0, v241, s[8:9]
    v_mfma_f32_16x16x32_f16 v[64:67], v[16:19], v[128:131], v[48:51]
    v_cvt_pk_bf16_f32 v144, v80, v81 clamp
    v_cvt_pk_bf16_f32 v145, v82, v83 clamp
    v_lshlrev_b32 v230, 16, v212
    v_and_b32 v231, s38, v212
    v_cvt_pk_f16_f32 v212, v230, v231
    v_mfma_f32_16x16x32_f16 v[64:67], v[20:23], v[132:135], v[64:67]
    v_cvt_pk_bf16_f32 v146, v84, v85 clamp
    v_cvt_pk_bf16_f32 v147, v86, v87 clamp
    v_lshlrev_b32 v230, 16, v213
    v_and_b32 v231, s38, v213
    v_cvt_pk_f16_f32 v213, v230, v231
    v_mfma_f32_16x16x32_f16 v[68:71], v[24:27], v[128:131], v[52:55]
    v_cvt_pk_bf16_f32 v148, v88, v89 clamp
    v_cvt_pk_bf16_f32 v149, v90, v91 clamp
    v_lshlrev_b32 v230, 16, v214
    v_and_b32 v231, s38, v214
    v_cvt_pk_f16_f32 v214, v230, v231
    v_mfma_f32_16x16x32_f16 v[68:71], v[28:31], v[132:135], v[68:71]
    v_cvt_pk_bf16_f32 v150, v92, v93 clamp
    v_cvt_pk_bf16_f32 v151, v94, v95 clamp
    v_lshlrev_b32 v230, 16, v215
    v_and_b32 v231, s38, v215
    v_cvt_pk_f16_f32 v215, v230, v231
    v_pk_maximum3_f16 v224, v220, v220, v224 neg_lo:[0,1,0] neg_hi:[0,1,0]
    v_pk_maximum3_f16 v224, v221, v221, v224 neg_lo:[0,1,0] neg_hi:[0,1,0]
    v_pk_maximum3_f16 v224, v222, v222, v224 neg_lo:[0,1,0] neg_hi:[0,1,0]
    v_pk_maximum3_f16 v224, v223, v223, v224 neg_lo:[0,1,0] neg_hi:[0,1,0]
    v_pk_maximum3_f16 v224, v212, v212, v224 neg_lo:[0,1,0] neg_hi:[0,1,0]
    v_pk_maximum3_f16 v224, v213, v213, v224 neg_lo:[0,1,0] neg_hi:[0,1,0]
    v_pk_maximum3_f16 v224, v214, v214, v224 neg_lo:[0,1,0] neg_hi:[0,1,0]
    v_pk_maximum3_f16 v224, v215, v215, v224 neg_lo:[0,1,0] neg_hi:[0,1,0]
    ds_write_b128 v235, v[212:215] offset:2304
    v_smfmac_f32_16x16x64_f16 v[8:11], v[184:187], v[128:135], v2
    ds_read_b128 v[104:107], v1 offset:720
    ds_read_b128 v[108:111], v1 offset:736
    v_mfma_f32_16x16x32_f16 v[72:75], v[32:35], v[128:131], v[56:59]
    s_waitcnt lgkmcnt(3)
    v_pk_mul_f16 v136, v96, v112
    v_pk_mul_f16 v137, v97, v113
    v_mfma_f32_16x16x32_f16 v[72:75], v[36:39], v[132:135], v[72:75]
    v_pk_mul_f16 v138, v98, v114
    v_pk_mul_f16 v139, v99, v115
    v_mfma_f32_16x16x32_f16 v[76:79], v[40:43], v[128:131], v[60:63]
    v_pk_mul_f16 v140, v100, v116
    v_pk_mul_f16 v141, v101, v117
    v_mfma_f32_16x16x32_f16 v[76:79], v[44:47], v[132:135], v[76:79]
    v_pk_mul_f16 v142, v102, v118
    v_pk_mul_f16 v143, v103, v119
    v_smfmac_f32_16x16x64_bf16 v[8:11], v[164:167], v[144:151], v2
    v_cndmask_b32 v188, 0, v238, s[18:19]
    v_cndmask_b32 v189, 0, v239, s[18:19]
    v_cndmask_b32 v190, 0, v240, s[18:19]
    v_cndmask_b32 v191, 0, v241, s[18:19]
    v_cndmask_b32 v172, 0, v238, s[10:11]
    v_cndmask_b32 v173, 0, v239, s[10:11]
    v_cndmask_b32 v174, 0, v240, s[10:11]
    v_cndmask_b32 v175, 0, v241, s[10:11]
    ds_write_b128 v235, v[200:203] offset:4896
    v_mfma_f32_16x16x32_f16 v[80:83], v[16:19], v[136:139], v[48:51]
    v_cvt_pk_bf16_f32 v144, v64, v65 clamp
    v_cvt_pk_bf16_f32 v145, v66, v67 clamp
    v_max_u32_sdwa v224, v224, v224 dst_sel:DWORD dst_unused:UNUSED_PAD src0_sel:WORD_0 src1_sel:WORD_1
    v_mfma_f32_16x16x32_f16 v[80:83], v[20:23], v[140:143], v[80:83]
    v_cvt_pk_bf16_f32 v146, v68, v69 clamp
    v_cvt_pk_bf16_f32 v147, v70, v71 clamp
    v_max_u32_dpp v224, v224, v224 row_ror:8 row_mask:0xf bank_mask:0xf
    v_mfma_f32_16x16x32_f16 v[84:87], v[24:27], v[136:139], v[52:55]
    v_cvt_pk_bf16_f32 v148, v72, v73 clamp
    v_cvt_pk_bf16_f32 v149, v74, v75 clamp
    v_max_u32_dpp v224, v224, v224 row_ror:4 row_mask:0xf bank_mask:0xf
    v_mfma_f32_16x16x32_f16 v[84:87], v[28:31], v[140:143], v[84:87]
    v_cvt_pk_bf16_f32 v150, v76, v77 clamp
    v_cvt_pk_bf16_f32 v151, v78, v79 clamp
    v_max_u32_dpp v224, v224, v224 row_ror:2 row_mask:0xf bank_mask:0xf
    v_smfmac_f32_16x16x64_f16 v[8:11], v[188:191], v[136:143], v2
    ds_read_b128 v[112:115], v1 offset:864
    ds_read_b128 v[116:119], v1 offset:880
    v_mov_b64 v[12:13], 0
    v_mfma_f32_16x16x32_f16 v[88:91], v[32:35], v[136:139], v[56:59]
    s_waitcnt lgkmcnt(3)
    v_pk_mul_f16 v128, v96, v104
    v_pk_mul_f16 v129, v97, v105
    v_max_u32_dpp v224, v224, v224 row_ror:1 row_mask:0xf bank_mask:0xf
    v_mfma_f32_16x16x32_f16 v[88:91], v[36:39], v[140:143], v[88:91]
    v_pk_mul_f16 v130, v98, v106
    v_pk_mul_f16 v131, v99, v107
    v_max_u32_dpp v224, v224, v224 row_bcast:15 row_mask:0xa bank_mask:0xf
    v_mfma_f32_16x16x32_f16 v[92:95], v[40:43], v[136:139], v[60:63]
    v_pk_mul_f16 v132, v100, v108
    v_pk_mul_f16 v133, v101, v109
    v_max_u32_dpp v224, v224, v224 row_bcast:31 row_mask:0xc bank_mask:0xf
    v_mfma_f32_16x16x32_f16 v[92:95], v[44:47], v[140:143], v[92:95]
    v_pk_mul_f16 v134, v102, v110
    v_pk_mul_f16 v135, v103, v111
    v_smfmac_f32_16x16x64_bf16 v[8:11], v[168:171], v[144:151], v2
    v_mov_b64 v[14:15], 0
    v_readlane_b32 s63, v224, 63
    s_sub_i32 s72, 6, s37
    s_lshl_b32 s72, s72, 10
    s_sub_i32 s73, 0x4c00, s72
    s_nop 0
    s_sub_i32 s72, s63, s72
    s_cmp_ge_u32 s72, s73
    s_cselect_b32 s72, 1, 0
    s_andn2_b32 s72, s72, s47
    s_cmp_lg_u32 s72, 0
    s_cbranch_scc1 L_slowE
    ds_write_b128 v236, v[204:207] offset:7200
    v_mov_b32 v7, s82
    v_add_u32_sdwa v3, v7, v228 dst_sel:DWORD dst_unused:UNUSED_PAD src0_sel:DWORD src1_sel:WORD_0
    v_add_u32_sdwa v4, v7, v228 dst_sel:DWORD dst_unused:UNUSED_PAD src0_sel:DWORD src1_sel:WORD_1
    v_add_u32_sdwa v6, v7, v229 dst_sel:DWORD dst_unused:UNUSED_PAD src0_sel:DWORD src1_sel:WORD_0
    v_add_u32_sdwa v226, v7, v229 dst_sel:DWORD dst_unused:UNUSED_PAD src0_sel:DWORD src1_sel:WORD_1
    v_mfma_f32_16x16x32_f16 v[64:67], v[16:19], v[128:131], v[48:51]
    v_cvt_pk_bf16_f32 v144, v80, v81 clamp
    v_cvt_pk_bf16_f32 v145, v82, v83 clamp
    v_mfma_f32_16x16x32_f16 v[64:67], v[20:23], v[132:135], v[64:67]
    v_cvt_pk_bf16_f32 v146, v84, v85 clamp
    v_cvt_pk_bf16_f32 v147, v86, v87 clamp
    v_mfma_f32_16x16x32_f16 v[68:71], v[24:27], v[128:131], v[52:55]
    v_cvt_pk_bf16_f32 v148, v88, v89 clamp
    v_cvt_pk_bf16_f32 v149, v90, v91 clamp
    v_mfma_f32_16x16x32_f16 v[68:71], v[28:31], v[132:135], v[68:71]
    v_cvt_pk_bf16_f32 v150, v92, v93 clamp
    v_cvt_pk_bf16_f32 v151, v94, v95 clamp
    v_smfmac_f32_16x16x64_f16 v[12:15], v[176:179], v[128:135], v2
    ds_read_b128 v[104:107], v1 offset:1008
    ds_read_b128 v[108:111], v1 offset:1024
    v_mfma_f32_16x16x32_f16 v[72:75], v[32:35], v[128:131], v[56:59]
    s_waitcnt lgkmcnt(3)
    v_pk_mul_f16 v136, v96, v112
    v_pk_mul_f16 v137, v97, v113
    v_mfma_f32_16x16x32_f16 v[72:75], v[36:39], v[132:135], v[72:75]
    v_pk_mul_f16 v138, v98, v114
    v_pk_mul_f16 v139, v99, v115
    v_mfma_f32_16x16x32_f16 v[76:79], v[40:43], v[128:131], v[60:63]
    v_pk_mul_f16 v140, v100, v116
    v_pk_mul_f16 v141, v101, v117
    v_mfma_f32_16x16x32_f16 v[76:79], v[44:47], v[132:135], v[76:79]
    v_pk_mul_f16 v142, v102, v118
    v_pk_mul_f16 v143, v103, v119
    v_smfmac_f32_16x16x64_bf16 v[8:11], v[172:175], v[144:151], v2
    ds_write_b128 v235, v[196:199] offset:3744
    s_lshr_b32 s62, s62, 7
    s_max_u32 s62, s62, 40
    s_sub_i32 s65, 141, s62
    s_add_i32 s65, s65, s36
    s_sub_i32 s69, 127, s64
    s_max_i32 s69, s69, 1
    s_min_i32 s69, s69, 227
    s_lshl_b32 s69, s69, 23
    s_or_b32 s69, s69, 0x38aa3b
    v_mfma_f32_16x16x32_f16 v[80:83], v[16:19], v[136:139], v[48:51]
    v_cvt_pk_bf16_f32 v144, v64, v65 clamp
    v_cvt_pk_bf16_f32 v145, v66, v67 clamp
    v_mfma_f32_16x16x32_f16 v[80:83], v[20:23], v[140:143], v[80:83]
    v_cvt_pk_bf16_f32 v146, v68, v69 clamp
    v_cvt_pk_bf16_f32 v147, v70, v71 clamp
    v_mfma_f32_16x16x32_f16 v[84:87], v[24:27], v[136:139], v[52:55]
    v_cvt_pk_bf16_f32 v148, v72, v73 clamp
    v_cvt_pk_bf16_f32 v149, v74, v75 clamp
    v_mfma_f32_16x16x32_f16 v[84:87], v[28:31], v[140:143], v[84:87]
    v_cvt_pk_bf16_f32 v150, v76, v77 clamp
    v_cvt_pk_bf16_f32 v151, v78, v79 clamp
    v_smfmac_f32_16x16x64_f16 v[12:15], v[180:183], v[136:143], v2
    ds_read_b128 v[112:115], v226 offset:0
    ds_read_b128 v[116:119], v226 offset:16
    v_add_f32 v192, v8, v9
    v_mfma_f32_16x16x32_f16 v[88:91], v[32:35], v[136:139], v[56:59]
    s_waitcnt lgkmcnt(3)
    v_pk_mul_f16 v128, v96, v104
    v_pk_mul_f16 v129, v97, v105
    v_mfma_f32_16x16x32_f16 v[88:91], v[36:39], v[140:143], v[88:91]
    v_pk_mul_f16 v130, v98, v106
    v_pk_mul_f16 v131, v99, v107
    v_mfma_f32_16x16x32_f16 v[92:95], v[40:43], v[136:139], v[60:63]
    v_pk_mul_f16 v132, v100, v108
    v_pk_mul_f16 v133, v101, v109
    v_mfma_f32_16x16x32_f16 v[92:95], v[44:47], v[140:143], v[92:95]
    v_pk_mul_f16 v134, v102, v110
    v_pk_mul_f16 v135, v103, v111
    v_smfmac_f32_16x16x64_bf16 v[12:15], v[160:163], v[144:151], v2
    v_add_f32 v203, v10, v11
    ds_write_b128 v235, v[208:211] offset:12672
    v_mfma_f32_16x16x32_f16 v[64:67], v[16:19], v[128:131], v[48:51]
    v_cvt_pk_bf16_f32 v144, v80, v81 clamp
    v_cvt_pk_bf16_f32 v145, v82, v83 clamp
    v_mfma_f32_16x16x32_f16 v[64:67], v[20:23], v[132:135], v[64:67]
    v_cvt_pk_bf16_f32 v146, v84, v85 clamp
    v_cvt_pk_bf16_f32 v147, v86, v87 clamp
    v_mfma_f32_16x16x32_f16 v[68:71], v[24:27], v[128:131], v[52:55]
    v_cvt_pk_bf16_f32 v148, v88, v89 clamp
    v_cvt_pk_bf16_f32 v149, v90, v91 clamp
    v_mfma_f32_16x16x32_f16 v[68:71], v[28:31], v[132:135], v[68:71]
    v_cvt_pk_bf16_f32 v150, v92, v93 clamp
    v_cvt_pk_bf16_f32 v151, v94, v95 clamp
    v_smfmac_f32_16x16x64_f16 v[12:15], v[184:187], v[128:135], v2
    ds_read_b128 v[104:107], v226 offset:144
    ds_read_b128 v[108:111], v226 offset:160
    v_mfma_f32_16x16x32_f16 v[72:75], v[32:35], v[128:131], v[56:59]
    s_waitcnt lgkmcnt(3)
    v_pk_mul_f16 v136, v96, v112
    v_pk_mul_f16 v137, v97, v113
    v_mfma_f32_16x16x32_f16 v[72:75], v[36:39], v[132:135], v[72:75]
    v_pk_mul_f16 v138, v98, v114
    v_pk_mul_f16 v139, v99, v115
    v_mfma_f32_16x16x32_f16 v[76:79], v[40:43], v[128:131], v[60:63]
    v_pk_mul_f16 v140, v100, v116
    v_pk_mul_f16 v141, v101, v117
    v_mfma_f32_16x16x32_f16 v[76:79], v[44:47], v[132:135], v[76:79]
    v_pk_mul_f16 v142, v102, v118
    v_pk_mul_f16 v143, v103, v119
    v_smfmac_f32_16x16x64_bf16 v[12:15], v[164:167], v[144:151], v2
    v_mfma_f32_16x16x32_f16 v[80:83], v[16:19], v[136:139], v[48:51]
    v_cvt_pk_bf16_f32 v144, v64, v65 clamp
    v_cvt_pk_bf16_f32 v145, v66, v67 clamp
    v_mfma_f32_16x16x32_f16 v[80:83], v[20:23], v[140:143], v[80:83]
    v_cvt_pk_bf16_f32 v146, v68, v69 clamp
    v_cvt_pk_bf16_f32 v147, v70, v71 clamp
    v_mfma_f32_16x16x32_f16 v[84:87], v[24:27], v[136:139], v[52:55]
    v_cvt_pk_bf16_f32 v148, v72, v73 clamp
    v_cvt_pk_bf16_f32 v149, v74, v75 clamp
    v_mfma_f32_16x16x32_f16 v[84:87], v[28:31], v[140:143], v[84:87]
    v_cvt_pk_bf16_f32 v150, v76, v77 clamp
    v_cvt_pk_bf16_f32 v151, v78, v79 clamp
    v_smfmac_f32_16x16x64_f16 v[12:15], v[188:191], v[136:143], v2
    ds_read_b128 v[112:115], v1 offset:1152
    ds_read_b128 v[116:119], v1 offset:1168
    v_mov_b64 v[8:9], 0
    v_mfma_f32_16x16x32_f16 v[88:91], v[32:35], v[136:139], v[56:59]
    s_waitcnt lgkmcnt(2)
    v_pk_mul_f16 v128, v96, v104
    v_pk_mul_f16 v129, v97, v105
    v_mfma_f32_16x16x32_f16 v[88:91], v[36:39], v[140:143], v[88:91]
    v_pk_mul_f16 v130, v98, v106
    v_pk_mul_f16 v131, v99, v107
    v_mfma_f32_16x16x32_f16 v[92:95], v[40:43], v[136:139], v[60:63]
    v_pk_mul_f16 v132, v100, v108
    v_pk_mul_f16 v133, v101, v109
    v_mfma_f32_16x16x32_f16 v[92:95], v[44:47], v[140:143], v[92:95]
    v_pk_mul_f16 v134, v102, v110
    v_pk_mul_f16 v135, v103, v111
    v_smfmac_f32_16x16x64_bf16 v[12:15], v[168:171], v[144:151], v2
    v_mov_b64 v[10:11], 0
    v_mfma_f32_16x16x32_f16 v[64:67], v[16:19], v[128:131], v[48:51]
    v_cvt_pk_bf16_f32 v144, v80, v81 clamp
    v_cvt_pk_bf16_f32 v145, v82, v83 clamp
    v_mfma_f32_16x16x32_f16 v[64:67], v[20:23], v[132:135], v[64:67]
    v_cvt_pk_bf16_f32 v146, v84, v85 clamp
    v_cvt_pk_bf16_f32 v147, v86, v87 clamp
    v_mfma_f32_16x16x32_f16 v[68:71], v[24:27], v[128:131], v[52:55]
    v_cvt_pk_bf16_f32 v148, v88, v89 clamp
    v_cvt_pk_bf16_f32 v149, v90, v91 clamp
    v_mfma_f32_16x16x32_f16 v[68:71], v[28:31], v[132:135], v[68:71]
    v_cvt_pk_bf16_f32 v150, v92, v93 clamp
    v_cvt_pk_bf16_f32 v151, v94, v95 clamp
    v_smfmac_f32_16x16x64_f16 v[8:11], v[176:179], v[128:135], v2
    ds_read_b128 v[104:107], v1 offset:1296
    ds_read_b128 v[108:111], v1 offset:1312
    v_mfma_f32_16x16x32_f16 v[72:75], v[32:35], v[128:131], v[56:59]
    s_waitcnt lgkmcnt(2)
    v_pk_mul_f16 v136, v96, v112
    v_pk_mul_f16 v137, v97, v113
    v_mfma_f32_16x16x32_f16 v[72:75], v[36:39], v[132:135], v[72:75]
    v_pk_mul_f16 v138, v98, v114
    v_pk_mul_f16 v139, v99, v115
    v_mfma_f32_16x16x32_f16 v[76:79], v[40:43], v[128:131], v[60:63]
    v_pk_mul_f16 v140, v100, v116
    v_pk_mul_f16 v141, v101, v117
    v_mfma_f32_16x16x32_f16 v[76:79], v[44:47], v[132:135], v[76:79]
    v_pk_mul_f16 v142, v102, v118
    v_pk_mul_f16 v143, v103, v119
    v_smfmac_f32_16x16x64_bf16 v[12:15], v[172:175], v[144:151], v2
    v_pk_mul_f16 v112, v112, s42
    v_pk_mul_f16 v113, v113, s42
    v_pk_mul_f16 v114, v114, s42
    v_pk_mul_f16 v115, v115, s42
    v_pk_mul_f16 v116, v116, s42
    v_pk_mul_f16 v117, v117, s42
    v_pk_mul_f16 v118, v118, s42
    v_pk_mul_f16 v119, v119, s42
    v_mfma_f32_16x16x32_f16 v[80:83], v[16:19], v[136:139], v[48:51]
    v_cvt_pk_bf16_f32 v144, v64, v65 clamp
    v_cvt_pk_bf16_f32 v145, v66, v67 clamp
    v_mfma_f32_16x16x32_f16 v[80:83], v[20:23], v[140:143], v[80:83]
    v_cvt_pk_bf16_f32 v146, v68, v69 clamp
    v_cvt_pk_bf16_f32 v147, v70, v71 clamp
    v_mfma_f32_16x16x32_f16 v[84:87], v[24:27], v[136:139], v[52:55]
    v_cvt_pk_bf16_f32 v148, v72, v73 clamp
    v_cvt_pk_bf16_f32 v149, v74, v75 clamp
    v_mfma_f32_16x16x32_f16 v[84:87], v[28:31], v[140:143], v[84:87]
    v_cvt_pk_bf16_f32 v150, v76, v77 clamp
    v_cvt_pk_bf16_f32 v151, v78, v79 clamp
    v_smfmac_f32_16x16x64_f16 v[8:11], v[180:183], v[136:143], v2
    v_add_f32 v193, v12, v13
    v_mfma_f32_16x16x32_f16 v[88:91], v[32:35], v[136:139], v[56:59]
    s_waitcnt lgkmcnt(0)
    v_pk_mul_f16 v128, v96, v104
    v_pk_mul_f16 v129, v97, v105
    v_mfma_f32_16x16x32_f16 v[88:91], v[36:39], v[140:143], v[88:91]
    v_pk_mul_f16 v130, v98, v106
    v_pk_mul_f16 v131, v99, v107
    v_mfma_f32_16x16x32_f16 v[92:95], v[40:43], v[136:139], v[60:63]
    v_pk_mul_f16 v132, v100, v108
    v_pk_mul_f16 v133, v101, v109
    v_mfma_f32_16x16x32_f16 v[92:95], v[44:47], v[140:143], v[92:95]
    v_pk_mul_f16 v134, v102, v110
    v_pk_mul_f16 v135, v103, v111
    v_smfmac_f32_16x16x64_bf16 v[8:11], v[160:163], v[144:151], v2
    v_add_f32 v204, v14, v15
    v_mfma_f32_16x16x32_f16 v[64:67], v[16:19], v[128:131], v[48:51]
    v_cvt_pk_bf16_f32 v144, v80, v81 clamp
    v_cvt_pk_bf16_f32 v145, v82, v83 clamp
    v_mfma_f32_16x16x32_f16 v[64:67], v[20:23], v[132:135], v[64:67]
    v_cvt_pk_bf16_f32 v146, v84, v85 clamp
    v_cvt_pk_bf16_f32 v147, v86, v87 clamp
    v_mfma_f32_16x16x32_f16 v[68:71], v[24:27], v[128:131], v[52:55]
    v_cvt_pk_bf16_f32 v148, v88, v89 clamp
    v_cvt_pk_bf16_f32 v149, v90, v91 clamp
    v_mfma_f32_16x16x32_f16 v[68:71], v[28:31], v[132:135], v[68:71]
    v_cvt_pk_bf16_f32 v150, v92, v93 clamp
    v_cvt_pk_bf16_f32 v151, v94, v95 clamp
    v_smfmac_f32_16x16x64_f16 v[8:11], v[184:187], v[128:135], v2
    ds_read_b128 v[120:123], v1 offset:1440
    ds_read_b128 v[124:127], v1 offset:1456
    v_mfma_f32_16x16x32_f16 v[72:75], v[32:35], v[128:131], v[56:59]
    v_pk_mul_f16 v136, v112, v104
    v_pk_mul_f16 v137, v113, v105
    v_mfma_f32_16x16x32_f16 v[72:75], v[36:39], v[132:135], v[72:75]
    v_pk_mul_f16 v138, v114, v106
    v_pk_mul_f16 v139, v115, v107
    v_mfma_f32_16x16x32_f16 v[76:79], v[40:43], v[128:131], v[60:63]
    v_pk_mul_f16 v140, v116, v108
    v_pk_mul_f16 v141, v117, v109
    v_mfma_f32_16x16x32_f16 v[76:79], v[44:47], v[132:135], v[76:79]
    v_pk_mul_f16 v142, v118, v110
    v_pk_mul_f16 v143, v119, v111
    v_smfmac_f32_16x16x64_bf16 v[8:11], v[164:167], v[144:151], v2
    v_mfma_f32_16x16x32_f16 v[80:83], v[16:19], v[136:139], v[48:51]
    v_cvt_pk_bf16_f32 v144, v64, v65 clamp
    v_cvt_pk_bf16_f32 v145, v66, v67 clamp
    v_mfma_f32_16x16x32_f16 v[80:83], v[20:23], v[140:143], v[80:83]
    v_cvt_pk_bf16_f32 v146, v68, v69 clamp
    v_cvt_pk_bf16_f32 v147, v70, v71 clamp
    v_mfma_f32_16x16x32_f16 v[84:87], v[24:27], v[136:139], v[52:55]
    v_cvt_pk_bf16_f32 v148, v72, v73 clamp
    v_cvt_pk_bf16_f32 v149, v74, v75 clamp
    v_mfma_f32_16x16x32_f16 v[84:87], v[28:31], v[140:143], v[84:87]
    v_cvt_pk_bf16_f32 v150, v76, v77 clamp
    v_cvt_pk_bf16_f32 v151, v78, v79 clamp
    v_smfmac_f32_16x16x64_f16 v[8:11], v[188:191], v[136:143], v2
    v_mov_b64 v[12:13], 0
    v_mfma_f32_16x16x32_f16 v[88:91], v[32:35], v[136:139], v[56:59]
    s_waitcnt lgkmcnt(0)
    v_pk_mul_f16 v128, v96, v120
    v_pk_mul_f16 v129, v97, v121
    v_mfma_f32_16x16x32_f16 v[88:91], v[36:39], v[140:143], v[88:91]
    v_pk_mul_f16 v130, v98, v122
    v_pk_mul_f16 v131, v99, v123
    v_mfma_f32_16x16x32_f16 v[92:95], v[40:43], v[136:139], v[60:63]
    v_pk_mul_f16 v132, v100, v124
    v_pk_mul_f16 v133, v101, v125
    v_mfma_f32_16x16x32_f16 v[92:95], v[44:47], v[140:143], v[92:95]
    v_pk_mul_f16 v134, v102, v126
    v_pk_mul_f16 v135, v103, v127
    v_smfmac_f32_16x16x64_bf16 v[8:11], v[168:171], v[144:151], v2
    v_mov_b64 v[14:15], 0
    v_mfma_f32_16x16x32_f16 v[64:67], v[16:19], v[128:131], v[48:51]
    v_cvt_pk_bf16_f32 v144, v80, v81 clamp
    v_cvt_pk_bf16_f32 v145, v82, v83 clamp
    v_mfma_f32_16x16x32_f16 v[64:67], v[20:23], v[132:135], v[64:67]
    v_cvt_pk_bf16_f32 v146, v84, v85 clamp
    v_cvt_pk_bf16_f32 v147, v86, v87 clamp
    v_mfma_f32_16x16x32_f16 v[68:71], v[24:27], v[128:131], v[52:55]
    v_cvt_pk_bf16_f32 v148, v88, v89 clamp
    v_cvt_pk_bf16_f32 v149, v90, v91 clamp
    v_mfma_f32_16x16x32_f16 v[68:71], v[28:31], v[132:135], v[68:71]
    v_cvt_pk_bf16_f32 v150, v92, v93 clamp
    v_cvt_pk_bf16_f32 v151, v94, v95 clamp
    v_smfmac_f32_16x16x64_f16 v[12:15], v[176:179], v[128:135], v2
    ds_read_b128 v[104:107], v1 offset:1584
    ds_read_b128 v[108:111], v1 offset:1600
    v_mfma_f32_16x16x32_f16 v[72:75], v[32:35], v[128:131], v[56:59]
    v_pk_mul_f16 v136, v112, v120
    v_pk_mul_f16 v137, v113, v121
    v_mfma_f32_16x16x32_f16 v[72:75], v[36:39], v[132:135], v[72:75]
    v_pk_mul_f16 v138, v114, v122
    v_pk_mul_f16 v139, v115, v123
    v_mfma_f32_16x16x32_f16 v[76:79], v[40:43], v[128:131], v[60:63]
    v_pk_mul_f16 v140, v116, v124
    v_pk_mul_f16 v141, v117, v125
    v_mfma_f32_16x16x32_f16 v[76:79], v[44:47], v[132:135], v[76:79]
    v_pk_mul_f16 v142, v118, v126
    v_pk_mul_f16 v143, v119, v127
    v_smfmac_f32_16x16x64_bf16 v[8:11], v[172:175], v[144:151], v2
    v_mfma_f32_16x16x32_f16 v[80:83], v[16:19], v[136:139], v[48:51]
    v_cvt_pk_bf16_f32 v144, v64, v65 clamp
    v_cvt_pk_bf16_f32 v145, v66, v67 clamp
    v_mfma_f32_16x16x32_f16 v[80:83], v[20:23], v[140:143], v[80:83]
    v_cvt_pk_bf16_f32 v146, v68, v69 clamp
    v_cvt_pk_bf16_f32 v147, v70, v71 clamp
    v_mfma_f32_16x16x32_f16 v[84:87], v[24:27], v[136:139], v[52:55]
    v_cvt_pk_bf16_f32 v148, v72, v73 clamp
    v_cvt_pk_bf16_f32 v149, v74, v75 clamp
    v_mfma_f32_16x16x32_f16 v[84:87], v[28:31], v[140:143], v[84:87]
    v_cvt_pk_bf16_f32 v150, v76, v77 clamp
    v_cvt_pk_bf16_f32 v151, v78, v79 clamp
    v_smfmac_f32_16x16x64_f16 v[12:15], v[180:183], v[136:143], v2
    v_add_f32 v194, v8, v9
    v_mfma_f32_16x16x32_f16 v[88:91], v[32:35], v[136:139], v[56:59]
    s_waitcnt lgkmcnt(0)
    v_pk_mul_f16 v128, v96, v104
    v_pk_mul_f16 v129, v97, v105
    v_mfma_f32_16x16x32_f16 v[88:91], v[36:39], v[140:143], v[88:91]
    v_pk_mul_f16 v130, v98, v106
    v_pk_mul_f16 v131, v99, v107
    v_mfma_f32_16x16x32_f16 v[92:95], v[40:43], v[136:139], v[60:63]
    v_pk_mul_f16 v132, v100, v108
    v_pk_mul_f16 v133, v101, v109
    v_mfma_f32_16x16x32_f16 v[92:95], v[44:47], v[140:143], v[92:95]
    v_pk_mul_f16 v134, v102, v110
    v_pk_mul_f16 v135, v103, v111
    v_smfmac_f32_16x16x64_bf16 v[12:15], v[160:163], v[144:151], v2
    v_add_f32 v205, v10, v11
    s_setprio 1
    v_mfma_f32_16x16x32_f16 v[64:67], v[16:19], v[128:131], v[48:51]
    v_cvt_pk_bf16_f32 v144, v80, v81 clamp
    v_cvt_pk_bf16_f32 v145, v82, v83 clamp
    v_mfma_f32_16x16x32_f16 v[64:67], v[20:23], v[132:135], v[64:67]
    v_cvt_pk_bf16_f32 v146, v84, v85 clamp
    v_cvt_pk_bf16_f32 v147, v86, v87 clamp
    v_mfma_f32_16x16x32_f16 v[68:71], v[24:27], v[128:131], v[52:55]
    v_cvt_pk_bf16_f32 v148, v88, v89 clamp
    v_cvt_pk_bf16_f32 v149, v90, v91 clamp
    v_mfma_f32_16x16x32_f16 v[68:71], v[28:31], v[132:135], v[68:71]
    v_cvt_pk_bf16_f32 v150, v92, v93 clamp
    v_cvt_pk_bf16_f32 v151, v94, v95 clamp
    v_smfmac_f32_16x16x64_f16 v[12:15], v[184:187], v[128:135], v2
    ds_read_b128 v[120:123], v1 offset:1728
    ds_read_b128 v[124:127], v1 offset:1744
    v_mfma_f32_16x16x32_f16 v[72:75], v[32:35], v[128:131], v[56:59]
    v_pk_mul_f16 v136, v112, v104
    v_pk_mul_f16 v137, v113, v105
    v_mfma_f32_16x16x32_f16 v[72:75], v[36:39], v[132:135], v[72:75]
    v_pk_mul_f16 v138, v114, v106
    v_pk_mul_f16 v139, v115, v107
    v_mfma_f32_16x16x32_f16 v[76:79], v[40:43], v[128:131], v[60:63]
    v_pk_mul_f16 v140, v116, v108
    v_pk_mul_f16 v141, v117, v109
    v_mfma_f32_16x16x32_f16 v[76:79], v[44:47], v[132:135], v[76:79]
    v_pk_mul_f16 v142, v118, v110
    v_pk_mul_f16 v143, v119, v111
    v_smfmac_f32_16x16x64_bf16 v[12:15], v[164:167], v[144:151], v2
    v_mfma_f32_16x16x32_f16 v[80:83], v[16:19], v[136:139], v[48:51]
    v_cvt_pk_bf16_f32 v144, v64, v65 clamp
    v_cvt_pk_bf16_f32 v145, v66, v67 clamp
    v_mfma_f32_16x16x32_f16 v[80:83], v[20:23], v[140:143], v[80:83]
    v_cvt_pk_bf16_f32 v146, v68, v69 clamp
    v_cvt_pk_bf16_f32 v147, v70, v71 clamp
    v_mfma_f32_16x16x32_f16 v[84:87], v[24:27], v[136:139], v[52:55]
    v_cvt_pk_bf16_f32 v148, v72, v73 clamp
    v_cvt_pk_bf16_f32 v149, v74, v75 clamp
    v_mfma_f32_16x16x32_f16 v[84:87], v[28:31], v[140:143], v[84:87]
    v_cvt_pk_bf16_f32 v150, v76, v77 clamp
    v_cvt_pk_bf16_f32 v151, v78, v79 clamp
    v_smfmac_f32_16x16x64_f16 v[12:15], v[188:191], v[136:143], v2
    v_mov_b64 v[8:9], 0
    v_mfma_f32_16x16x32_f16 v[88:91], v[32:35], v[136:139], v[56:59]
    s_waitcnt lgkmcnt(0)
    v_pk_mul_f16 v128, v96, v120
    v_pk_mul_f16 v129, v97, v121
    v_mfma_f32_16x16x32_f16 v[88:91], v[36:39], v[140:143], v[88:91]
    v_pk_mul_f16 v130, v98, v122
    v_pk_mul_f16 v131, v99, v123
    v_mfma_f32_16x16x32_f16 v[92:95], v[40:43], v[136:139], v[60:63]
    v_pk_mul_f16 v132, v100, v124
    v_pk_mul_f16 v133, v101, v125
    v_mfma_f32_16x16x32_f16 v[92:95], v[44:47], v[140:143], v[92:95]
    v_pk_mul_f16 v134, v102, v126
    v_pk_mul_f16 v135, v103, v127
    v_smfmac_f32_16x16x64_bf16 v[12:15], v[168:171], v[144:151], v2
    v_mov_b64 v[10:11], 0
    v_mfma_f32_16x16x32_f16 v[64:67], v[16:19], v[128:131], v[48:51]
    v_cvt_pk_bf16_f32 v144, v80, v81 clamp
    v_cvt_pk_bf16_f32 v145, v82, v83 clamp
    v_mfma_f32_16x16x32_f16 v[64:67], v[20:23], v[132:135], v[64:67]
    v_cvt_pk_bf16_f32 v146, v84, v85 clamp
    v_cvt_pk_bf16_f32 v147, v86, v87 clamp
    v_mfma_f32_16x16x32_f16 v[68:71], v[24:27], v[128:131], v[52:55]
    v_cvt_pk_bf16_f32 v148, v88, v89 clamp
    v_cvt_pk_bf16_f32 v149, v90, v91 clamp
    v_mfma_f32_16x16x32_f16 v[68:71], v[28:31], v[132:135], v[68:71]
    v_cvt_pk_bf16_f32 v150, v92, v93 clamp
    v_cvt_pk_bf16_f32 v151, v94, v95 clamp
    v_smfmac_f32_16x16x64_f16 v[8:11], v[176:179], v[128:135], v2
    ds_read_b128 v[104:107], v1 offset:1872
    ds_read_b128 v[108:111], v1 offset:1888
    v_mfma_f32_16x16x32_f16 v[72:75], v[32:35], v[128:131], v[56:59]
    v_pk_mul_f16 v136, v112, v120
    v_pk_mul_f16 v137, v113, v121
    v_mfma_f32_16x16x32_f16 v[72:75], v[36:39], v[132:135], v[72:75]
    v_pk_mul_f16 v138, v114, v122
    v_pk_mul_f16 v139, v115, v123
    v_mfma_f32_16x16x32_f16 v[76:79], v[40:43], v[128:131], v[60:63]
    v_pk_mul_f16 v140, v116, v124
    v_pk_mul_f16 v141, v117, v125
    v_mfma_f32_16x16x32_f16 v[76:79], v[44:47], v[132:135], v[76:79]
    v_pk_mul_f16 v142, v118, v126
    v_pk_mul_f16 v143, v119, v127
    v_smfmac_f32_16x16x64_bf16 v[12:15], v[172:175], v[144:151], v2
    v_mfma_f32_16x16x32_f16 v[80:83], v[16:19], v[136:139], v[48:51]
    v_cvt_pk_bf16_f32 v144, v64, v65 clamp
    v_cvt_pk_bf16_f32 v145, v66, v67 clamp
    v_mfma_f32_16x16x32_f16 v[80:83], v[20:23], v[140:143], v[80:83]
    v_cvt_pk_bf16_f32 v146, v68, v69 clamp
    v_cvt_pk_bf16_f32 v147, v70, v71 clamp
    v_mfma_f32_16x16x32_f16 v[84:87], v[24:27], v[136:139], v[52:55]
    v_cvt_pk_bf16_f32 v148, v72, v73 clamp
    v_cvt_pk_bf16_f32 v149, v74, v75 clamp
    v_mfma_f32_16x16x32_f16 v[84:87], v[28:31], v[140:143], v[84:87]
    v_cvt_pk_bf16_f32 v150, v76, v77 clamp
    v_cvt_pk_bf16_f32 v151, v78, v79 clamp
    v_smfmac_f32_16x16x64_f16 v[8:11], v[180:183], v[136:143], v2
    v_add_f32 v195, v12, v13
    v_mfma_f32_16x16x32_f16 v[88:91], v[32:35], v[136:139], v[56:59]
    s_waitcnt lgkmcnt(0)
    v_pk_mul_f16 v128, v96, v104
    v_pk_mul_f16 v129, v97, v105
    v_mfma_f32_16x16x32_f16 v[88:91], v[36:39], v[140:143], v[88:91]
    v_pk_mul_f16 v130, v98, v106
    v_pk_mul_f16 v131, v99, v107
    v_mfma_f32_16x16x32_f16 v[92:95], v[40:43], v[136:139], v[60:63]
    v_pk_mul_f16 v132, v100, v108
    v_pk_mul_f16 v133, v101, v109
    v_mfma_f32_16x16x32_f16 v[92:95], v[44:47], v[140:143], v[92:95]
    v_pk_mul_f16 v134, v102, v110
    v_pk_mul_f16 v135, v103, v111
    v_smfmac_f32_16x16x64_bf16 v[8:11], v[160:163], v[144:151], v2
    v_add_f32 v206, v14, v15
    v_mfma_f32_16x16x32_f16 v[64:67], v[16:19], v[128:131], v[48:51]
    v_cvt_pk_bf16_f32 v144, v80, v81 clamp
    v_cvt_pk_bf16_f32 v145, v82, v83 clamp
    v_mfma_f32_16x16x32_f16 v[64:67], v[20:23], v[132:135], v[64:67]
    v_cvt_pk_bf16_f32 v146, v84, v85 clamp
    v_cvt_pk_bf16_f32 v147, v86, v87 clamp
    v_mfma_f32_16x16x32_f16 v[68:71], v[24:27], v[128:131], v[52:55]
    v_cvt_pk_bf16_f32 v148, v88, v89 clamp
    v_cvt_pk_bf16_f32 v149, v90, v91 clamp
    v_mfma_f32_16x16x32_f16 v[68:71], v[28:31], v[132:135], v[68:71]
    v_cvt_pk_bf16_f32 v150, v92, v93 clamp
    v_cvt_pk_bf16_f32 v151, v94, v95 clamp
    v_smfmac_f32_16x16x64_f16 v[8:11], v[184:187], v[128:135], v2
    ds_read_b128 v[96:99], v1 offset:2016
    ds_read_b128 v[100:103], v1 offset:2032
    v_mfma_f32_16x16x32_f16 v[72:75], v[32:35], v[128:131], v[56:59]
    v_pk_mul_f16 v136, v112, v104
    v_pk_mul_f16 v137, v113, v105
    v_mfma_f32_16x16x32_f16 v[72:75], v[36:39], v[132:135], v[72:75]
    v_pk_mul_f16 v138, v114, v106
    v_pk_mul_f16 v139, v115, v107
    v_mfma_f32_16x16x32_f16 v[76:79], v[40:43], v[128:131], v[60:63]
    v_pk_mul_f16 v140, v116, v108
    v_pk_mul_f16 v141, v117, v109
    v_mfma_f32_16x16x32_f16 v[76:79], v[44:47], v[132:135], v[76:79]
    v_pk_mul_f16 v142, v118, v110
    v_pk_mul_f16 v143, v119, v111
    v_smfmac_f32_16x16x64_bf16 v[8:11], v[164:167], v[144:151], v2
    v_mfma_f32_16x16x32_f16 v[80:83], v[16:19], v[136:139], v[48:51]
    v_cvt_pk_bf16_f32 v144, v64, v65 clamp
    v_cvt_pk_bf16_f32 v145, v66, v67 clamp
    v_mfma_f32_16x16x32_f16 v[80:83], v[20:23], v[140:143], v[80:83]
    v_cvt_pk_bf16_f32 v146, v68, v69 clamp
    v_cvt_pk_bf16_f32 v147, v70, v71 clamp
    v_mfma_f32_16x16x32_f16 v[84:87], v[24:27], v[136:139], v[52:55]
    v_cvt_pk_bf16_f32 v148, v72, v73 clamp
    v_cvt_pk_bf16_f32 v149, v74, v75 clamp
    v_mfma_f32_16x16x32_f16 v[84:87], v[28:31], v[140:143], v[84:87]
    v_cvt_pk_bf16_f32 v150, v76, v77 clamp
    v_cvt_pk_bf16_f32 v151, v78, v79 clamp
    v_smfmac_f32_16x16x64_f16 v[8:11], v[188:191], v[136:143], v2
    ds_read_b128 v[104:107], v1 offset:2160
    ds_read_b128 v[108:111], v1 offset:2176
    v_mov_b64 v[12:13], 0
    v_mfma_f32_16x16x32_f16 v[88:91], v[32:35], v[136:139], v[56:59]
    s_waitcnt lgkmcnt(2)
    v_pk_mul_f16 v128, v112, v96
    v_pk_mul_f16 v129, v113, v97
    v_mfma_f32_16x16x32_f16 v[88:91], v[36:39], v[140:143], v[88:91]
    v_pk_mul_f16 v130, v114, v98
    v_pk_mul_f16 v131, v115, v99
    v_mfma_f32_16x16x32_f16 v[92:95], v[40:43], v[136:139], v[60:63]
    v_pk_mul_f16 v132, v116, v100
    v_pk_mul_f16 v133, v117, v101
    v_mfma_f32_16x16x32_f16 v[92:95], v[44:47], v[140:143], v[92:95]
    v_pk_mul_f16 v134, v118, v102
    v_pk_mul_f16 v135, v119, v103
    v_smfmac_f32_16x16x64_bf16 v[8:11], v[168:171], v[144:151], v2
    v_mov_b64 v[14:15], 0
    v_mfma_f32_16x16x32_f16 v[64:67], v[16:19], v[128:131], v[48:51]
    v_cvt_pk_bf16_f32 v144, v80, v81 clamp
    v_cvt_pk_bf16_f32 v145, v82, v83 clamp
    v_mfma_f32_16x16x32_f16 v[64:67], v[20:23], v[132:135], v[64:67]
    v_cvt_pk_bf16_f32 v146, v84, v85 clamp
    v_cvt_pk_bf16_f32 v147, v86, v87 clamp
    v_mfma_f32_16x16x32_f16 v[68:71], v[24:27], v[128:131], v[52:55]
    v_cvt_pk_bf16_f32 v148, v88, v89 clamp
    v_cvt_pk_bf16_f32 v149, v90, v91 clamp
    v_mfma_f32_16x16x32_f16 v[68:71], v[28:31], v[132:135], v[68:71]
    v_cvt_pk_bf16_f32 v150, v92, v93 clamp
    v_cvt_pk_bf16_f32 v151, v94, v95 clamp
    v_smfmac_f32_16x16x64_f16 v[12:15], v[176:179], v[128:135], v2
    ds_read_b128 v[96:99], v1 offset:2304
    ds_read_b128 v[100:103], v1 offset:2320
    v_mfma_f32_16x16x32_f16 v[72:75], v[32:35], v[128:131], v[56:59]
    s_waitcnt lgkmcnt(2)
    v_pk_mul_f16 v136, v112, v104
    v_pk_mul_f16 v137, v113, v105
    v_mfma_f32_16x16x32_f16 v[72:75], v[36:39], v[132:135], v[72:75]
    v_pk_mul_f16 v138, v114, v106
    v_pk_mul_f16 v139, v115, v107
    v_mfma_f32_16x16x32_f16 v[76:79], v[40:43], v[128:131], v[60:63]
    v_pk_mul_f16 v140, v116, v108
    v_pk_mul_f16 v141, v117, v109
    v_mfma_f32_16x16x32_f16 v[76:79], v[44:47], v[132:135], v[76:79]
    v_pk_mul_f16 v142, v118, v110
    v_pk_mul_f16 v143, v119, v111
    v_smfmac_f32_16x16x64_bf16 v[8:11], v[172:175], v[144:151], v2
    v_mfma_f32_16x16x32_f16 v[80:83], v[16:19], v[136:139], v[48:51]
    v_cvt_pk_bf16_f32 v144, v64, v65 clamp
    v_cvt_pk_bf16_f32 v145, v66, v67 clamp
    v_mfma_f32_16x16x32_f16 v[80:83], v[20:23], v[140:143], v[80:83]
    v_cvt_pk_bf16_f32 v146, v68, v69 clamp
    v_cvt_pk_bf16_f32 v147, v70, v71 clamp
    v_mfma_f32_16x16x32_f16 v[84:87], v[24:27], v[136:139], v[52:55]
    v_cvt_pk_bf16_f32 v148, v72, v73 clamp
    v_cvt_pk_bf16_f32 v149, v74, v75 clamp
    v_mfma_f32_16x16x32_f16 v[84:87], v[28:31], v[140:143], v[84:87]
    v_cvt_pk_bf16_f32 v150, v76, v77 clamp
    v_cvt_pk_bf16_f32 v151, v78, v79 clamp
    v_smfmac_f32_16x16x64_f16 v[12:15], v[180:183], v[136:143], v2
    ds_read_b128 v[104:107], v3 offset:0
    ds_read_b128 v[108:111], v3 offset:16
    v_add_f32 v196, v8, v9
    v_mfma_f32_16x16x32_f16 v[88:91], v[32:35], v[136:139], v[56:59]
    s_waitcnt lgkmcnt(2)
    v_pk_mul_f16 v128, v112, v96
    v_pk_mul_f16 v129, v113, v97
    v_mfma_f32_16x16x32_f16 v[88:91], v[36:39], v[140:143], v[88:91]
    v_pk_mul_f16 v130, v114, v98
    v_pk_mul_f16 v131, v115, v99
    v_mfma_f32_16x16x32_f16 v[92:95], v[40:43], v[136:139], v[60:63]
    v_pk_mul_f16 v132, v116, v100
    v_pk_mul_f16 v133, v117, v101
    v_mfma_f32_16x16x32_f16 v[92:95], v[44:47], v[140:143], v[92:95]
    v_pk_mul_f16 v134, v118, v102
    v_pk_mul_f16 v135, v119, v103
    v_smfmac_f32_16x16x64_bf16 v[12:15], v[160:163], v[144:151], v2
    v_add_f32 v207, v10, v11
    v_mfma_f32_16x16x32_f16 v[64:67], v[16:19], v[128:131], v[48:51]
    v_cvt_pk_bf16_f32 v144, v80, v81 clamp
    v_cvt_pk_bf16_f32 v145, v82, v83 clamp
    v_mfma_f32_16x16x32_f16 v[64:67], v[20:23], v[132:135], v[64:67]
    v_cvt_pk_bf16_f32 v146, v84, v85 clamp
    v_cvt_pk_bf16_f32 v147, v86, v87 clamp
    v_mfma_f32_16x16x32_f16 v[68:71], v[24:27], v[128:131], v[52:55]
    v_cvt_pk_bf16_f32 v148, v88, v89 clamp
    v_cvt_pk_bf16_f32 v149, v90, v91 clamp
    v_mfma_f32_16x16x32_f16 v[68:71], v[28:31], v[132:135], v[68:71]
    v_cvt_pk_bf16_f32 v150, v92, v93 clamp
    v_cvt_pk_bf16_f32 v151, v94, v95 clamp
    v_smfmac_f32_16x16x64_f16 v[12:15], v[184:187], v[128:135], v2
    ds_read_b128 v[120:123], v1 offset:2448
    ds_read_b128 v[124:127], v1 offset:2464
    v_mfma_f32_16x16x32_f16 v[72:75], v[32:35], v[128:131], v[56:59]
    s_waitcnt lgkmcnt(2)
    v_pk_mul_f16 v136, v112, v104
    v_pk_mul_f16 v137, v113, v105
    v_mfma_f32_16x16x32_f16 v[72:75], v[36:39], v[132:135], v[72:75]
    v_pk_mul_f16 v138, v114, v106
    v_pk_mul_f16 v139, v115, v107
    v_mfma_f32_16x16x32_f16 v[76:79], v[40:43], v[128:131], v[60:63]
    v_pk_mul_f16 v140, v116, v108
    v_pk_mul_f16 v141, v117, v109
    v_mfma_f32_16x16x32_f16 v[76:79], v[44:47], v[132:135], v[76:79]
    v_pk_mul_f16 v142, v118, v110
    v_pk_mul_f16 v143, v119, v111
    v_smfmac_f32_16x16x64_bf16 v[12:15], v[164:167], v[144:151], v2
    v_pk_mul_f16 v96, v96, s42
    v_pk_mul_f16 v97, v97, s42
    v_pk_mul_f16 v98, v98, s42
    v_pk_mul_f16 v99, v99, s42
    v_pk_mul_f16 v100, v100, s42
    v_pk_mul_f16 v101, v101, s42
    v_pk_mul_f16 v102, v102, s42
    v_pk_mul_f16 v103, v103, s42
    v_mfma_f32_16x16x32_f16 v[80:83], v[16:19], v[136:139], v[48:51]
    v_cvt_pk_bf16_f32 v144, v64, v65 clamp
    v_cvt_pk_bf16_f32 v145, v66, v67 clamp
    v_mfma_f32_16x16x32_f16 v[80:83], v[20:23], v[140:143], v[80:83]
    v_cvt_pk_bf16_f32 v146, v68, v69 clamp
    v_cvt_pk_bf16_f32 v147, v70, v71 clamp
    v_mfma_f32_16x16x32_f16 v[84:87], v[24:27], v[136:139], v[52:55]
    v_cvt_pk_bf16_f32 v148, v72, v73 clamp
    v_cvt_pk_bf16_f32 v149, v74, v75 clamp
    v_mfma_f32_16x16x32_f16 v[84:87], v[28:31], v[140:143], v[84:87]
    v_cvt_pk_bf16_f32 v150, v76, v77 clamp
    v_cvt_pk_bf16_f32 v151, v78, v79 clamp
    v_smfmac_f32_16x16x64_f16 v[12:15], v[188:191], v[136:143], v2
    v_mov_b64 v[8:9], 0
    v_mfma_f32_16x16x32_f16 v[88:91], v[32:35], v[136:139], v[56:59]
    s_waitcnt lgkmcnt(0)
    v_pk_mul_f16 v128, v112, v120
    v_pk_mul_f16 v129, v113, v121
    v_mfma_f32_16x16x32_f16 v[88:91], v[36:39], v[140:143], v[88:91]
    v_pk_mul_f16 v130, v114, v122
    v_pk_mul_f16 v131, v115, v123
    v_mfma_f32_16x16x32_f16 v[92:95], v[40:43], v[136:139], v[60:63]
    v_pk_mul_f16 v132, v116, v124
    v_pk_mul_f16 v133, v117, v125
    v_mfma_f32_16x16x32_f16 v[92:95], v[44:47], v[140:143], v[92:95]
    v_pk_mul_f16 v134, v118, v126
    v_pk_mul_f16 v135, v119, v127
    v_smfmac_f32_16x16x64_bf16 v[12:15], v[168:171], v[144:151], v2
    v_mov_b64 v[10:11], 0
    v_mfma_f32_16x16x32_f16 v[64:67], v[16:19], v[128:131], v[48:51]
    v_cvt_pk_bf16_f32 v144, v80, v81 clamp
    v_cvt_pk_bf16_f32 v145, v82, v83 clamp
    v_mfma_f32_16x16x32_f16 v[64:67], v[20:23], v[132:135], v[64:67]
    v_cvt_pk_bf16_f32 v146, v84, v85 clamp
    v_cvt_pk_bf16_f32 v147, v86, v87 clamp
    v_mfma_f32_16x16x32_f16 v[68:71], v[24:27], v[128:131], v[52:55]
    v_cvt_pk_bf16_f32 v148, v88, v89 clamp
    v_cvt_pk_bf16_f32 v149, v90, v91 clamp
    v_mfma_f32_16x16x32_f16 v[68:71], v[28:31], v[132:135], v[68:71]
    v_cvt_pk_bf16_f32 v150, v92, v93 clamp
    v_cvt_pk_bf16_f32 v151, v94, v95 clamp
    v_smfmac_f32_16x16x64_f16 v[8:11], v[176:179], v[128:135], v2
    ds_read_b128 v[104:107], v1 offset:2592
    ds_read_b128 v[108:111], v1 offset:2608
    v_mfma_f32_16x16x32_f16 v[72:75], v[32:35], v[128:131], v[56:59]
    v_pk_mul_f16 v136, v96, v120
    v_pk_mul_f16 v137, v97, v121
    v_mfma_f32_16x16x32_f16 v[72:75], v[36:39], v[132:135], v[72:75]
    v_pk_mul_f16 v138, v98, v122
    v_pk_mul_f16 v139, v99, v123
    v_mfma_f32_16x16x32_f16 v[76:79], v[40:43], v[128:131], v[60:63]
    v_pk_mul_f16 v140, v100, v124
    v_pk_mul_f16 v141, v101, v125
    v_mfma_f32_16x16x32_f16 v[76:79], v[44:47], v[132:135], v[76:79]
    v_pk_mul_f16 v142, v102, v126
    v_pk_mul_f16 v143, v103, v127
    v_smfmac_f32_16x16x64_bf16 v[12:15], v[172:175], v[144:151], v2
    v_mfma_f32_16x16x32_f16 v[80:83], v[16:19], v[136:139], v[48:51]
    v_cvt_pk_bf16_f32 v144, v64, v65 clamp
    v_cvt_pk_bf16_f32 v145, v66, v67 clamp
    v_mfma_f32_16x16x32_f16 v[80:83], v[20:23], v[140:143], v[80:83]
    v_cvt_pk_bf16_f32 v146, v68, v69 clamp
    v_cvt_pk_bf16_f32 v147, v70, v71 clamp
    v_mfma_f32_16x16x32_f16 v[84:87], v[24:27], v[136:139], v[52:55]
    v_cvt_pk_bf16_f32 v148, v72, v73 clamp
    v_cvt_pk_bf16_f32 v149, v74, v75 clamp
    v_mfma_f32_16x16x32_f16 v[84:87], v[28:31], v[140:143], v[84:87]
    v_cvt_pk_bf16_f32 v150, v76, v77 clamp
    v_cvt_pk_bf16_f32 v151, v78, v79 clamp
    v_smfmac_f32_16x16x64_f16 v[8:11], v[180:183], v[136:143], v2
    v_add_f32 v197, v12, v13
    v_mfma_f32_16x16x32_f16 v[88:91], v[32:35], v[136:139], v[56:59]
    s_waitcnt lgkmcnt(0)
    v_pk_mul_f16 v128, v112, v104
    v_pk_mul_f16 v129, v113, v105
    v_mfma_f32_16x16x32_f16 v[88:91], v[36:39], v[140:143], v[88:91]
    v_pk_mul_f16 v130, v114, v106
    v_pk_mul_f16 v131, v115, v107
    v_mfma_f32_16x16x32_f16 v[92:95], v[40:43], v[136:139], v[60:63]
    v_pk_mul_f16 v132, v116, v108
    v_pk_mul_f16 v133, v117, v109
    v_mfma_f32_16x16x32_f16 v[92:95], v[44:47], v[140:143], v[92:95]
    v_pk_mul_f16 v134, v118, v110
    v_pk_mul_f16 v135, v119, v111
    v_smfmac_f32_16x16x64_bf16 v[8:11], v[160:163], v[144:151], v2
    v_add_f32 v208, v14, v15
    v_mfma_f32_16x16x32_f16 v[64:67], v[16:19], v[128:131], v[48:51]
    v_cvt_pk_bf16_f32 v144, v80, v81 clamp
    v_cvt_pk_bf16_f32 v145, v82, v83 clamp
    v_mfma_f32_16x16x32_f16 v[64:67], v[20:23], v[132:135], v[64:67]
    v_cvt_pk_bf16_f32 v146, v84, v85 clamp
    v_cvt_pk_bf16_f32 v147, v86, v87 clamp
    v_mfma_f32_16x16x32_f16 v[68:71], v[24:27], v[128:131], v[52:55]
    v_cvt_pk_bf16_f32 v148, v88, v89 clamp
    v_cvt_pk_bf16_f32 v149, v90, v91 clamp
    v_mfma_f32_16x16x32_f16 v[68:71], v[28:31], v[132:135], v[68:71]
    v_cvt_pk_bf16_f32 v150, v92, v93 clamp
    v_cvt_pk_bf16_f32 v151, v94, v95 clamp
    v_smfmac_f32_16x16x64_f16 v[8:11], v[184:187], v[128:135], v2
    ds_read_b128 v[120:123], v1 offset:2736
    ds_read_b128 v[124:127], v1 offset:2752
    v_mfma_f32_16x16x32_f16 v[72:75], v[32:35], v[128:131], v[56:59]
    v_pk_mul_f16 v136, v96, v104
    v_pk_mul_f16 v137, v97, v105
    v_mfma_f32_16x16x32_f16 v[72:75], v[36:39], v[132:135], v[72:75]
    v_pk_mul_f16 v138, v98, v106
    v_pk_mul_f16 v139, v99, v107
    v_mfma_f32_16x16x32_f16 v[76:79], v[40:43], v[128:131], v[60:63]
    v_pk_mul_f16 v140, v100, v108
    v_pk_mul_f16 v141, v101, v109
    v_mfma_f32_16x16x32_f16 v[76:79], v[44:47], v[132:135], v[76:79]
    v_pk_mul_f16 v142, v102, v110
    v_pk_mul_f16 v143, v103, v111
    v_smfmac_f32_16x16x64_bf16 v[8:11], v[164:167], v[144:151], v2
    v_mfma_f32_16x16x32_f16 v[80:83], v[16:19], v[136:139], v[48:51]
    v_cvt_pk_bf16_f32 v144, v64, v65 clamp
    v_cvt_pk_bf16_f32 v145, v66, v67 clamp
    v_mfma_f32_16x16x32_f16 v[80:83], v[20:23], v[140:143], v[80:83]
    v_cvt_pk_bf16_f32 v146, v68, v69 clamp
    v_cvt_pk_bf16_f32 v147, v70, v71 clamp
    v_mfma_f32_16x16x32_f16 v[84:87], v[24:27], v[136:139], v[52:55]
    v_cvt_pk_bf16_f32 v148, v72, v73 clamp
    v_cvt_pk_bf16_f32 v149, v74, v75 clamp
    v_mfma_f32_16x16x32_f16 v[84:87], v[28:31], v[140:143], v[84:87]
    v_cvt_pk_bf16_f32 v150, v76, v77 clamp
    v_cvt_pk_bf16_f32 v151, v78, v79 clamp
    v_smfmac_f32_16x16x64_f16 v[8:11], v[188:191], v[136:143], v2
    v_mov_b64 v[12:13], 0
    v_mfma_f32_16x16x32_f16 v[88:91], v[32:35], v[136:139], v[56:59]
    s_waitcnt lgkmcnt(0)
    v_pk_mul_f16 v128, v112, v120
    v_pk_mul_f16 v129, v113, v121
    v_mfma_f32_16x16x32_f16 v[88:91], v[36:39], v[140:143], v[88:91]
    v_pk_mul_f16 v130, v114, v122
    v_pk_mul_f16 v131, v115, v123
    v_mfma_f32_16x16x32_f16 v[92:95], v[40:43], v[136:139], v[60:63]
    v_pk_mul_f16 v132, v116, v124
    v_pk_mul_f16 v133, v117, v125
    v_mfma_f32_16x16x32_f16 v[92:95], v[44:47], v[140:143], v[92:95]
    v_pk_mul_f16 v134, v118, v126
    v_pk_mul_f16 v135, v119, v127
    v_smfmac_f32_16x16x64_bf16 v[8:11], v[168:171], v[144:151], v2
    v_mov_b64 v[14:15], 0
    s_setprio 0
    v_mfma_f32_16x16x32_f16 v[64:67], v[16:19], v[128:131], v[48:51]
    v_cvt_pk_bf16_f32 v144, v80, v81 clamp
    v_cvt_pk_bf16_f32 v145, v82, v83 clamp
    v_mfma_f32_16x16x32_f16 v[64:67], v[20:23], v[132:135], v[64:67]
    v_cvt_pk_bf16_f32 v146, v84, v85 clamp
    v_cvt_pk_bf16_f32 v147, v86, v87 clamp
    v_mfma_f32_16x16x32_f16 v[68:71], v[24:27], v[128:131], v[52:55]
    v_cvt_pk_bf16_f32 v148, v88, v89 clamp
    v_cvt_pk_bf16_f32 v149, v90, v91 clamp
    v_mfma_f32_16x16x32_f16 v[68:71], v[28:31], v[132:135], v[68:71]
    v_cvt_pk_bf16_f32 v150, v92, v93 clamp
    v_cvt_pk_bf16_f32 v151, v94, v95 clamp
    v_smfmac_f32_16x16x64_f16 v[12:15], v[176:179], v[128:135], v2
    ds_read_b128 v[104:107], v1 offset:2880
    ds_read_b128 v[108:111], v1 offset:2896
    v_mfma_f32_16x16x32_f16 v[72:75], v[32:35], v[128:131], v[56:59]
    v_pk_mul_f16 v136, v96, v120
    v_pk_mul_f16 v137, v97, v121
    v_mfma_f32_16x16x32_f16 v[72:75], v[36:39], v[132:135], v[72:75]
    v_pk_mul_f16 v138, v98, v122
    v_pk_mul_f16 v139, v99, v123
    v_mfma_f32_16x16x32_f16 v[76:79], v[40:43], v[128:131], v[60:63]
    v_pk_mul_f16 v140, v100, v124
    v_pk_mul_f16 v141, v101, v125
    v_mfma_f32_16x16x32_f16 v[76:79], v[44:47], v[132:135], v[76:79]
    v_pk_mul_f16 v142, v102, v126
    v_pk_mul_f16 v143, v103, v127
    v_smfmac_f32_16x16x64_bf16 v[8:11], v[172:175], v[144:151], v2
    v_mfma_f32_16x16x32_f16 v[80:83], v[16:19], v[136:139], v[48:51]
    v_cvt_pk_bf16_f32 v144, v64, v65 clamp
    v_cvt_pk_bf16_f32 v145, v66, v67 clamp
    v_mfma_f32_16x16x32_f16 v[80:83], v[20:23], v[140:143], v[80:83]
    v_cvt_pk_bf16_f32 v146, v68, v69 clamp
    v_cvt_pk_bf16_f32 v147, v70, v71 clamp
    v_mfma_f32_16x16x32_f16 v[84:87], v[24:27], v[136:139], v[52:55]
    v_cvt_pk_bf16_f32 v148, v72, v73 clamp
    v_cvt_pk_bf16_f32 v149, v74, v75 clamp
    v_mfma_f32_16x16x32_f16 v[84:87], v[28:31], v[140:143], v[84:87]
    v_cvt_pk_bf16_f32 v150, v76, v77 clamp
    v_cvt_pk_bf16_f32 v151, v78, v79 clamp
    v_smfmac_f32_16x16x64_f16 v[12:15], v[180:183], v[136:143], v2
    v_add_f32 v198, v8, v9
    v_mfma_f32_16x16x32_f16 v[88:91], v[32:35], v[136:139], v[56:59]
    s_waitcnt lgkmcnt(0)
    v_pk_mul_f16 v128, v112, v104
    v_pk_mul_f16 v129, v113, v105
    v_mfma_f32_16x16x32_f16 v[88:91], v[36:39], v[140:143], v[88:91]
    v_pk_mul_f16 v130, v114, v106
    v_pk_mul_f16 v131, v115, v107
    v_mfma_f32_16x16x32_f16 v[92:95], v[40:43], v[136:139], v[60:63]
    v_pk_mul_f16 v132, v116, v108
    v_pk_mul_f16 v133, v117, v109
    v_mfma_f32_16x16x32_f16 v[92:95], v[44:47], v[140:143], v[92:95]
    v_pk_mul_f16 v134, v118, v110
    v_pk_mul_f16 v135, v119, v111
    v_smfmac_f32_16x16x64_bf16 v[12:15], v[160:163], v[144:151], v2
    v_add_f32 v209, v10, v11
    v_mfma_f32_16x16x32_f16 v[64:67], v[16:19], v[128:131], v[48:51]
    v_cvt_pk_bf16_f32 v144, v80, v81 clamp
    v_cvt_pk_bf16_f32 v145, v82, v83 clamp
    v_mfma_f32_16x16x32_f16 v[64:67], v[20:23], v[132:135], v[64:67]
    v_cvt_pk_bf16_f32 v146, v84, v85 clamp
    v_cvt_pk_bf16_f32 v147, v86, v87 clamp
    v_mfma_f32_16x16x32_f16 v[68:71], v[24:27], v[128:131], v[52:55]
    v_cvt_pk_bf16_f32 v148, v88, v89 clamp
    v_cvt_pk_bf16_f32 v149, v90, v91 clamp
    v_mfma_f32_16x16x32_f16 v[68:71], v[28:31], v[132:135], v[68:71]
    v_cvt_pk_bf16_f32 v150, v92, v93 clamp
    v_cvt_pk_bf16_f32 v151, v94, v95 clamp
    v_smfmac_f32_16x16x64_f16 v[12:15], v[184:187], v[128:135], v2
    ds_read_b128 v[112:115], v1 offset:3024
    ds_read_b128 v[116:119], v1 offset:3040
    v_mfma_f32_16x16x32_f16 v[72:75], v[32:35], v[128:131], v[56:59]
    v_pk_mul_f16 v136, v96, v104
    v_pk_mul_f16 v137, v97, v105
    v_mfma_f32_16x16x32_f16 v[72:75], v[36:39], v[132:135], v[72:75]
    v_pk_mul_f16 v138, v98, v106
    v_pk_mul_f16 v139, v99, v107
    v_mfma_f32_16x16x32_f16 v[76:79], v[40:43], v[128:131], v[60:63]
    v_pk_mul_f16 v140, v100, v108
    v_pk_mul_f16 v141, v101, v109
    v_mfma_f32_16x16x32_f16 v[76:79], v[44:47], v[132:135], v[76:79]
    v_pk_mul_f16 v142, v102, v110
    v_pk_mul_f16 v143, v103, v111
    v_smfmac_f32_16x16x64_bf16 v[12:15], v[164:167], v[144:151], v2
    v_mfma_f32_16x16x32_f16 v[80:83], v[16:19], v[136:139], v[48:51]
    v_cvt_pk_bf16_f32 v144, v64, v65 clamp
    v_cvt_pk_bf16_f32 v145, v66, v67 clamp
    v_mfma_f32_16x16x32_f16 v[80:83], v[20:23], v[140:143], v[80:83]
    v_cvt_pk_bf16_f32 v146, v68, v69 clamp
    v_cvt_pk_bf16_f32 v147, v70, v71 clamp
    v_mfma_f32_16x16x32_f16 v[84:87], v[24:27], v[136:139], v[52:55]
    v_cvt_pk_bf16_f32 v148, v72, v73 clamp
    v_cvt_pk_bf16_f32 v149, v74, v75 clamp
    v_mfma_f32_16x16x32_f16 v[84:87], v[28:31], v[140:143], v[84:87]
    v_cvt_pk_bf16_f32 v150, v76, v77 clamp
    v_cvt_pk_bf16_f32 v151, v78, v79 clamp
    v_smfmac_f32_16x16x64_f16 v[12:15], v[188:191], v[136:143], v2
    ds_read_b128 v[104:107], v1 offset:3168
    ds_read_b128 v[108:111], v1 offset:3184
    v_mov_b64 v[8:9], 0
    v_mfma_f32_16x16x32_f16 v[88:91], v[32:35], v[136:139], v[56:59]
    s_waitcnt lgkmcnt(2)
    v_pk_mul_f16 v128, v96, v112
    v_pk_mul_f16 v129, v97, v113
    v_mfma_f32_16x16x32_f16 v[88:91], v[36:39], v[140:143], v[88:91]
    v_pk_mul_f16 v130, v98, v114
    v_pk_mul_f16 v131, v99, v115
    v_mfma_f32_16x16x32_f16 v[92:95], v[40:43], v[136:139], v[60:63]
    v_pk_mul_f16 v132, v100, v116
    v_pk_mul_f16 v133, v101, v117
    v_mfma_f32_16x16x32_f16 v[92:95], v[44:47], v[140:143], v[92:95]
    v_pk_mul_f16 v134, v102, v118
    v_pk_mul_f16 v135, v103, v119
    v_smfmac_f32_16x16x64_bf16 v[12:15], v[168:171], v[144:151], v2
    v_mov_b64 v[10:11], 0
    v_mfma_f32_16x16x32_f16 v[64:67], v[16:19], v[128:131], v[48:51]
    v_cvt_pk_bf16_f32 v144, v80, v81 clamp
    v_cvt_pk_bf16_f32 v145, v82, v83 clamp
    v_mfma_f32_16x16x32_f16 v[64:67], v[20:23], v[132:135], v[64:67]
    v_cvt_pk_bf16_f32 v146, v84, v85 clamp
    v_cvt_pk_bf16_f32 v147, v86, v87 clamp
    v_mfma_f32_16x16x32_f16 v[68:71], v[24:27], v[128:131], v[52:55]
    v_cvt_pk_bf16_f32 v148, v88, v89 clamp
    v_cvt_pk_bf16_f32 v149, v90, v91 clamp
    v_mfma_f32_16x16x32_f16 v[68:71], v[28:31], v[132:135], v[68:71]
    v_cvt_pk_bf16_f32 v150, v92, v93 clamp
    v_cvt_pk_bf16_f32 v151, v94, v95 clamp
    v_smfmac_f32_16x16x64_f16 v[8:11], v[176:179], v[128:135], v2
    ds_read_b128 v[112:115], v1 offset:3312
    ds_read_b128 v[116:119], v1 offset:3328
    v_mfma_f32_16x16x32_f16 v[72:75], v[32:35], v[128:131], v[56:59]
    s_waitcnt lgkmcnt(2)
    v_pk_mul_f16 v136, v96, v104
    v_pk_mul_f16 v137, v97, v105
    v_mfma_f32_16x16x32_f16 v[72:75], v[36:39], v[132:135], v[72:75]
    v_pk_mul_f16 v138, v98, v106
    v_pk_mul_f16 v139, v99, v107
    v_mfma_f32_16x16x32_f16 v[76:79], v[40:43], v[128:131], v[60:63]
    v_pk_mul_f16 v140, v100, v108
    v_pk_mul_f16 v141, v101, v109
    v_mfma_f32_16x16x32_f16 v[76:79], v[44:47], v[132:135], v[76:79]
    v_pk_mul_f16 v142, v102, v110
    v_pk_mul_f16 v143, v103, v111
    v_smfmac_f32_16x16x64_bf16 v[12:15], v[172:175], v[144:151], v2
    v_mfma_f32_16x16x32_f16 v[80:83], v[16:19], v[136:139], v[48:51]
    v_cvt_pk_bf16_f32 v144, v64, v65 clamp
    v_cvt_pk_bf16_f32 v145, v66, v67 clamp
    v_mfma_f32_16x16x32_f16 v[80:83], v[20:23], v[140:143], v[80:83]
    v_cvt_pk_bf16_f32 v146, v68, v69 clamp
    v_cvt_pk_bf16_f32 v147, v70, v71 clamp
    v_mfma_f32_16x16x32_f16 v[84:87], v[24:27], v[136:139], v[52:55]
    v_cvt_pk_bf16_f32 v148, v72, v73 clamp
    v_cvt_pk_bf16_f32 v149, v74, v75 clamp
    v_mfma_f32_16x16x32_f16 v[84:87], v[28:31], v[140:143], v[84:87]
    v_cvt_pk_bf16_f32 v150, v76, v77 clamp
    v_cvt_pk_bf16_f32 v151, v78, v79 clamp
    v_smfmac_f32_16x16x64_f16 v[8:11], v[180:183], v[136:143], v2
    ds_read_b128 v[104:107], v1 offset:3456
    ds_read_b128 v[108:111], v1 offset:3472
    v_add_f32 v199, v12, v13
    v_mfma_f32_16x16x32_f16 v[88:91], v[32:35], v[136:139], v[56:59]
    s_waitcnt lgkmcnt(2)
    v_pk_mul_f16 v128, v96, v112
    v_pk_mul_f16 v129, v97, v113
    v_mfma_f32_16x16x32_f16 v[88:91], v[36:39], v[140:143], v[88:91]
    v_pk_mul_f16 v130, v98, v114
    v_pk_mul_f16 v131, v99, v115
    v_mfma_f32_16x16x32_f16 v[92:95], v[40:43], v[136:139], v[60:63]
    v_pk_mul_f16 v132, v100, v116
    v_pk_mul_f16 v133, v101, v117
    v_mfma_f32_16x16x32_f16 v[92:95], v[44:47], v[140:143], v[92:95]
    v_pk_mul_f16 v134, v102, v118
    v_pk_mul_f16 v135, v103, v119
    v_smfmac_f32_16x16x64_bf16 v[8:11], v[160:163], v[144:151], v2
    v_add_f32 v210, v14, v15
    v_mfma_f32_16x16x32_f16 v[64:67], v[16:19], v[128:131], v[48:51]
    v_cvt_pk_bf16_f32 v144, v80, v81 clamp
    v_cvt_pk_bf16_f32 v145, v82, v83 clamp
    v_mfma_f32_16x16x32_f16 v[64:67], v[20:23], v[132:135], v[64:67]
    v_cvt_pk_bf16_f32 v146, v84, v85 clamp
    v_cvt_pk_bf16_f32 v147, v86, v87 clamp
    v_mfma_f32_16x16x32_f16 v[68:71], v[24:27], v[128:131], v[52:55]
    v_cvt_pk_bf16_f32 v148, v88, v89 clamp
    v_cvt_pk_bf16_f32 v149, v90, v91 clamp
    v_mfma_f32_16x16x32_f16 v[68:71], v[28:31], v[132:135], v[68:71]
    v_cvt_pk_bf16_f32 v150, v92, v93 clamp
    v_cvt_pk_bf16_f32 v151, v94, v95 clamp
    v_smfmac_f32_16x16x64_f16 v[8:11], v[184:187], v[128:135], v2
    ds_read_b128 v[112:115], v1 offset:3600
    ds_read_b128 v[116:119], v1 offset:3616
    v_mfma_f32_16x16x32_f16 v[72:75], v[32:35], v[128:131], v[56:59]
    s_waitcnt lgkmcnt(2)
    v_pk_mul_f16 v136, v96, v104
    v_pk_mul_f16 v137, v97, v105
    v_mfma_f32_16x16x32_f16 v[72:75], v[36:39], v[132:135], v[72:75]
    v_pk_mul_f16 v138, v98, v106
    v_pk_mul_f16 v139, v99, v107
    v_mfma_f32_16x16x32_f16 v[76:79], v[40:43], v[128:131], v[60:63]
    v_pk_mul_f16 v140, v100, v108
    v_pk_mul_f16 v141, v101, v109
    v_mfma_f32_16x16x32_f16 v[76:79], v[44:47], v[132:135], v[76:79]
    v_pk_mul_f16 v142, v102, v110
    v_pk_mul_f16 v143, v103, v111
    v_smfmac_f32_16x16x64_bf16 v[8:11], v[164:167], v[144:151], v2
    v_mfma_f32_16x16x32_f16 v[80:83], v[16:19], v[136:139], v[48:51]
    v_cvt_pk_bf16_f32 v144, v64, v65 clamp
    v_cvt_pk_bf16_f32 v145, v66, v67 clamp
    v_mfma_f32_16x16x32_f16 v[80:83], v[20:23], v[140:143], v[80:83]
    v_cvt_pk_bf16_f32 v146, v68, v69 clamp
    v_cvt_pk_bf16_f32 v147, v70, v71 clamp
    v_mfma_f32_16x16x32_f16 v[84:87], v[24:27], v[136:139], v[52:55]
    v_cvt_pk_bf16_f32 v148, v72, v73 clamp
    v_cvt_pk_bf16_f32 v149, v74, v75 clamp
    v_mfma_f32_16x16x32_f16 v[84:87], v[28:31], v[140:143], v[84:87]
    v_cvt_pk_bf16_f32 v150, v76, v77 clamp
    v_cvt_pk_bf16_f32 v151, v78, v79 clamp
    v_smfmac_f32_16x16x64_f16 v[8:11], v[188:191], v[136:143], v2
    ds_read_b128 v[104:107], v1 offset:3744
    ds_read_b128 v[108:111], v1 offset:3760
    v_mov_b64 v[12:13], 0
    v_mfma_f32_16x16x32_f16 v[88:91], v[32:35], v[136:139], v[56:59]
    s_waitcnt lgkmcnt(2)
    v_pk_mul_f16 v128, v96, v112
    v_pk_mul_f16 v129, v97, v113
    v_mfma_f32_16x16x32_f16 v[88:91], v[36:39], v[140:143], v[88:91]
    v_pk_mul_f16 v130, v98, v114
    v_pk_mul_f16 v131, v99, v115
    v_mfma_f32_16x16x32_f16 v[92:95], v[40:43], v[136:139], v[60:63]
    v_pk_mul_f16 v132, v100, v116
    v_pk_mul_f16 v133, v101, v117
    v_mfma_f32_16x16x32_f16 v[92:95], v[44:47], v[140:143], v[92:95]
    v_pk_mul_f16 v134, v102, v118
    v_pk_mul_f16 v135, v103, v119
    v_smfmac_f32_16x16x64_bf16 v[8:11], v[168:171], v[144:151], v2
    v_mov_b64 v[14:15], 0
    v_mfma_f32_16x16x32_f16 v[64:67], v[16:19], v[128:131], v[48:51]
    v_cvt_pk_bf16_f32 v144, v80, v81 clamp
    v_cvt_pk_bf16_f32 v145, v82, v83 clamp
    v_mfma_f32_16x16x32_f16 v[64:67], v[20:23], v[132:135], v[64:67]
    v_cvt_pk_bf16_f32 v146, v84, v85 clamp
    v_cvt_pk_bf16_f32 v147, v86, v87 clamp
    v_mfma_f32_16x16x32_f16 v[68:71], v[24:27], v[128:131], v[52:55]
    v_cvt_pk_bf16_f32 v148, v88, v89 clamp
    v_cvt_pk_bf16_f32 v149, v90, v91 clamp
    v_mfma_f32_16x16x32_f16 v[68:71], v[28:31], v[132:135], v[68:71]
    v_cvt_pk_bf16_f32 v150, v92, v93 clamp
    v_cvt_pk_bf16_f32 v151, v94, v95 clamp
    v_smfmac_f32_16x16x64_f16 v[12:15], v[176:179], v[128:135], v2
    ds_read_b128 v[112:115], v1 offset:3888
    ds_read_b128 v[116:119], v1 offset:3904
    v_mfma_f32_16x16x32_f16 v[72:75], v[32:35], v[128:131], v[56:59]
    s_waitcnt lgkmcnt(2)
    v_pk_mul_f16 v136, v96, v104
    v_pk_mul_f16 v137, v97, v105
    v_mfma_f32_16x16x32_f16 v[72:75], v[36:39], v[132:135], v[72:75]
    v_pk_mul_f16 v138, v98, v106
    v_pk_mul_f16 v139, v99, v107
    v_mfma_f32_16x16x32_f16 v[76:79], v[40:43], v[128:131], v[60:63]
    v_pk_mul_f16 v140, v100, v108
    v_pk_mul_f16 v141, v101, v109
    v_mfma_f32_16x16x32_f16 v[76:79], v[44:47], v[132:135], v[76:79]
    v_pk_mul_f16 v142, v102, v110
    v_pk_mul_f16 v143, v103, v111
    v_smfmac_f32_16x16x64_bf16 v[8:11], v[172:175], v[144:151], v2
    v_mfma_f32_16x16x32_f16 v[80:83], v[16:19], v[136:139], v[48:51]
    v_cvt_pk_bf16_f32 v144, v64, v65 clamp
    v_cvt_pk_bf16_f32 v145, v66, v67 clamp
    v_mfma_f32_16x16x32_f16 v[80:83], v[20:23], v[140:143], v[80:83]
    v_cvt_pk_bf16_f32 v146, v68, v69 clamp
    v_cvt_pk_bf16_f32 v147, v70, v71 clamp
    v_mfma_f32_16x16x32_f16 v[84:87], v[24:27], v[136:139], v[52:55]
    v_cvt_pk_bf16_f32 v148, v72, v73 clamp
    v_cvt_pk_bf16_f32 v149, v74, v75 clamp
    v_mfma_f32_16x16x32_f16 v[84:87], v[28:31], v[140:143], v[84:87]
    v_cvt_pk_bf16_f32 v150, v76, v77 clamp
    v_cvt_pk_bf16_f32 v151, v78, v79 clamp
    v_smfmac_f32_16x16x64_f16 v[12:15], v[180:183], v[136:143], v2
    ds_read_b128 v[104:107], v1 offset:4032
    ds_read_b128 v[108:111], v1 offset:4048
    v_add_f32 v200, v8, v9
    v_mfma_f32_16x16x32_f16 v[88:91], v[32:35], v[136:139], v[56:59]
    s_waitcnt lgkmcnt(2)
    v_pk_mul_f16 v128, v96, v112
    v_pk_mul_f16 v129, v97, v113
    v_mfma_f32_16x16x32_f16 v[88:91], v[36:39], v[140:143], v[88:91]
    v_pk_mul_f16 v130, v98, v114
    v_pk_mul_f16 v131, v99, v115
    v_mfma_f32_16x16x32_f16 v[92:95], v[40:43], v[136:139], v[60:63]
    v_pk_mul_f16 v132, v100, v116
    v_pk_mul_f16 v133, v101, v117
    v_mfma_f32_16x16x32_f16 v[92:95], v[44:47], v[140:143], v[92:95]
    v_pk_mul_f16 v134, v102, v118
    v_pk_mul_f16 v135, v103, v119
    v_smfmac_f32_16x16x64_bf16 v[12:15], v[160:163], v[144:151], v2
    v_add_f32 v211, v10, v11
    v_mfma_f32_16x16x32_f16 v[64:67], v[16:19], v[128:131], v[48:51]
    ds_read_b128 v[120:123], v6 offset:0
    v_cvt_pk_bf16_f32 v144, v80, v81 clamp
    v_cvt_pk_bf16_f32 v145, v82, v83 clamp
    s_mov_b32 s72, 4294967295
    s_mov_b32 s73, 930349055
    v_mov_b32 v224, 0xff7fffff
    v_mfma_f32_16x16x32_f16 v[64:67], v[20:23], v[132:135], v[64:67]
    ds_read_b128 v[124:127], v6 offset:16
    v_cvt_pk_bf16_f32 v146, v84, v85 clamp
    v_cvt_pk_bf16_f32 v147, v86, v87 clamp
    v_cndmask_b32 v197, v224, v197, s[72:73]
    v_max3_f32 v232, v192, v193, v194
    v_max3_f32 v232, v232, v195, v196
    v_mfma_f32_16x16x32_f16 v[68:71], v[24:27], v[128:131], v[52:55]
    v_cvt_pk_bf16_f32 v148, v88, v89 clamp
    v_cvt_pk_bf16_f32 v149, v90, v91 clamp
    v_max3_f32 v232, v232, v197, v198
    v_max3_f32 v232, v232, v199, v200
    v_mul_f32 v233, s69, v232
    v_mfma_f32_16x16x32_f16 v[68:71], v[28:31], v[132:135], v[68:71]
    v_cvt_pk_bf16_f32 v150, v92, v93 clamp
    v_cvt_pk_bf16_f32 v151, v94, v95 clamp
    v_fma_f32 v192, v192, s69, -v233
    v_fma_f32 v193, v193, s69, -v233
    v_fma_f32 v194, v194, s69, -v233
    v_smfmac_f32_16x16x64_f16 v[12:15], v[184:187], v[128:135], v2
    ds_read_b128 v[112:115], v4 offset:0
    ds_read_b128 v[116:119], v4 offset:16
    v_mfma_f32_16x16x32_f16 v[72:75], v[32:35], v[128:131], v[56:59]
    s_waitcnt lgkmcnt(4)
    v_pk_mul_f16 v136, v96, v104
    v_pk_mul_f16 v137, v97, v105
    v_fma_f32 v195, v195, s69, -v233
    v_mfma_f32_16x16x32_f16 v[72:75], v[36:39], v[132:135], v[72:75]
    v_pk_mul_f16 v138, v98, v106
    v_pk_mul_f16 v139, v99, v107
    v_fma_f32 v196, v196, s69, -v233
    v_mfma_f32_16x16x32_f16 v[76:79], v[40:43], v[128:131], v[60:63]
    v_pk_mul_f16 v140, v100, v108
    v_pk_mul_f16 v141, v101, v109
    v_fma_f32 v197, v197, s69, -v233
    v_mfma_f32_16x16x32_f16 v[76:79], v[44:47], v[132:135], v[76:79]
    v_pk_mul_f16 v142, v102, v110
    v_pk_mul_f16 v143, v103, v111
    v_fma_f32 v198, v198, s69, -v233
    v_fma_f32 v199, v199, s69, -v233
    v_smfmac_f32_16x16x64_bf16 v[12:15], v[164:167], v[144:151], v2
    v_fma_f32 v200, v200, s69, -v233
    v_mfma_f32_16x16x32_f16 v[80:83], v[16:19], v[136:139], v[48:51]
    v_cvt_pk_bf16_f32 v144, v64, v65 clamp
    v_cvt_pk_bf16_f32 v145, v66, v67 clamp
    v_exp_f32 v192, v192
    v_exp_f32 v193, v193
    v_exp_f32 v194, v194
    v_mfma_f32_16x16x32_f16 v[80:83], v[20:23], v[140:143], v[80:83]
    v_cvt_pk_bf16_f32 v146, v68, v69 clamp
    v_cvt_pk_bf16_f32 v147, v70, v71 clamp
    v_exp_f32 v195, v195
    v_exp_f32 v196, v196
    v_exp_f32 v197, v197
    v_mfma_f32_16x16x32_f16 v[84:87], v[24:27], v[136:139], v[52:55]
    v_cvt_pk_bf16_f32 v148, v72, v73 clamp
    v_cvt_pk_bf16_f32 v149, v74, v75 clamp
    v_exp_f32 v198, v198
    v_exp_f32 v199, v199
    v_exp_f32 v200, v200
    v_mfma_f32_16x16x32_f16 v[84:87], v[28:31], v[140:143], v[84:87]
    v_cvt_pk_bf16_f32 v150, v76, v77 clamp
    v_cvt_pk_bf16_f32 v151, v78, v79 clamp
    v_smfmac_f32_16x16x64_f16 v[12:15], v[188:191], v[136:143], v2
    v_mov_b64 v[8:9], 0
    v_mfma_f32_16x16x32_f16 v[88:91], v[32:35], v[136:139], v[56:59]
    s_waitcnt lgkmcnt(0)
    v_pk_mul_f16 v112, v112, s42
    v_pk_mul_f16 v113, v113, s42
    v_pk_mul_f16 v114, v114, s42
    v_pk_mul_f16 v115, v115, s42
    v_pk_mul_f16 v116, v116, s42
    v_pk_mul_f16 v117, v117, s42
    v_pk_mul_f16 v118, v118, s42
    v_pk_mul_f16 v119, v119, s42
    v_pk_mul_f16 v128, v112, v120
    v_pk_mul_f16 v129, v113, v121
    v_mfma_f32_16x16x32_f16 v[88:91], v[36:39], v[140:143], v[88:91]
    v_pk_mul_f16 v130, v114, v122
    v_pk_mul_f16 v131, v115, v123
    v_mfma_f32_16x16x32_f16 v[92:95], v[40:43], v[136:139], v[60:63]
    v_pk_mul_f16 v132, v116, v124
    v_pk_mul_f16 v133, v117, v125
    v_mfma_f32_16x16x32_f16 v[92:95], v[44:47], v[140:143], v[92:95]
    v_pk_mul_f16 v134, v118, v126
    v_pk_mul_f16 v135, v119, v127
    v_smfmac_f32_16x16x64_bf16 v[12:15], v[168:171], v[144:151], v2
    v_mov_b64 v[10:11], 0
    v_mfma_f32_16x16x32_f16 v[64:67], v[16:19], v[128:131], v[48:51]
    v_cvt_pk_bf16_f32 v144, v80, v81 clamp
    v_cvt_pk_bf16_f32 v145, v82, v83 clamp
    v_add_f32 v234, v192, v193
    v_mul_f32 v235, v192, v203
    v_fmac_f32 v235, v193, v204
    v_mfma_f32_16x16x32_f16 v[64:67], v[20:23], v[132:135], v[64:67]
    v_cvt_pk_bf16_f32 v146, v84, v85 clamp
    v_cvt_pk_bf16_f32 v147, v86, v87 clamp
    v_add_f32 v234, v234, v194
    v_fmac_f32 v235, v194, v205
    v_add_f32 v234, v234, v195
    v_mfma_f32_16x16x32_f16 v[68:71], v[24:27], v[128:131], v[52:55]
    v_cvt_pk_bf16_f32 v148, v88, v89 clamp
    v_cvt_pk_bf16_f32 v149, v90, v91 clamp
    v_fmac_f32 v235, v195, v206
    v_add_f32 v234, v234, v196
    v_fmac_f32 v235, v196, v207
    v_mfma_f32_16x16x32_f16 v[68:71], v[28:31], v[132:135], v[68:71]
    v_cvt_pk_bf16_f32 v150, v92, v93 clamp
    v_cvt_pk_bf16_f32 v151, v94, v95 clamp
    v_add_f32 v234, v234, v197
    v_fmac_f32 v235, v197, v208
    v_add_f32 v234, v234, v198
    v_smfmac_f32_16x16x64_f16 v[8:11], v[176:179], v[128:135], v2
    v_mfma_f32_16x16x32_f16 v[72:75], v[32:35], v[128:131], v[56:59]
    v_fmac_f32 v235, v198, v209
    v_mfma_f32_16x16x32_f16 v[72:75], v[36:39], v[132:135], v[72:75]
    v_add_f32 v234, v234, v199
    v_mfma_f32_16x16x32_f16 v[76:79], v[40:43], v[128:131], v[60:63]
    v_fmac_f32 v235, v199, v210
    v_mfma_f32_16x16x32_f16 v[76:79], v[44:47], v[132:135], v[76:79]
    v_add_f32 v234, v234, v200
    v_fmac_f32 v235, v200, v211
    v_smfmac_f32_16x16x64_bf16 v[12:15], v[172:175], v[144:151], v2
    v_cvt_pk_bf16_f32 v144, v64, v65 clamp
    v_cvt_pk_bf16_f32 v145, v66, v67 clamp
    v_cvt_pk_bf16_f32 v146, v68, v69 clamp
    v_cvt_pk_bf16_f32 v147, v70, v71 clamp
    v_cvt_pk_bf16_f32 v148, v72, v73 clamp
    v_cvt_pk_bf16_f32 v149, v74, v75 clamp
    v_cvt_pk_bf16_f32 v150, v76, v77 clamp
    v_cvt_pk_bf16_f32 v151, v78, v79 clamp
    v_add_f32 v201, v12, v13
    s_nop 0
    v_smfmac_f32_16x16x64_bf16 v[8:11], v[160:163], v[144:151], v2
    v_add_f32 v212, v14, v15
    s_nop 6
    v_add_f32 v202, v8, v9
    v_add_f32 v213, v10, v11
    s_mov_b32 s80, 0xffff
    s_mov_b32 s81, 0
    v_cndmask_b32 v202, v224, v202, s[80:81]
    v_max3_f32 v225, v232, v201, v202
    s_nop 1
    v_max_f32_dpp v225, v225, v225 quad_perm:[1,0,3,2] row_mask:0xf bank_mask:0xf
    s_nop 1
    v_max_f32_dpp v225, v225, v225 quad_perm:[2,3,0,1] row_mask:0xf bank_mask:0xf
    s_nop 1
    v_max_f32_dpp v225, v225, v225 row_half_mirror row_mask:0xf bank_mask:0xf
    v_mov_b32 v226, v225
    s_nop 1
    v_permlane16_swap_b32 v225, v226
    v_max_f32 v225, v225, v226
    v_mov_b32 v226, v225
    s_nop 1
    v_permlane32_swap_b32 v225, v226
    v_max_f32 v225, v225, v226
    v_mul_f32 v225, s69, v225
    v_fma_f32 v201, v201, s69, -v225
    v_fma_f32 v202, v202, s69, -v225
    v_sub_f32 v233, v233, v225
    v_exp_f32 v201, v201
    v_exp_f32 v202, v202
    v_exp_f32 v233, v233
    v_add_f32 v227, v201, v202
    v_mul_f32 v228, v201, v212
    v_fmac_f32 v227, v234, v233
    v_fmac_f32 v228, v202, v213
    v_fmac_f32 v228, v235, v233
    v_add_f32_dpp v227, v227, v227 quad_perm:[1,0,3,2] row_mask:0xf bank_mask:0xf
    s_nop 0
    v_add_f32_dpp v228, v228, v228 quad_perm:[1,0,3,2] row_mask:0xf bank_mask:0xf
    v_add_f32_dpp v227, v227, v227 quad_perm:[2,3,0,1] row_mask:0xf bank_mask:0xf
    s_nop 0
    v_add_f32_dpp v228, v228, v228 quad_perm:[2,3,0,1] row_mask:0xf bank_mask:0xf
    v_add_f32_dpp v227, v227, v227 row_half_mirror row_mask:0xf bank_mask:0xf
    s_nop 0
    v_add_f32_dpp v228, v228, v228 row_half_mirror row_mask:0xf bank_mask:0xf
    v_mov_b32 v229, v227
    v_mov_b32 v230, v228
    s_nop 0
    v_permlane16_swap_b32 v227, v229
    v_permlane16_swap_b32 v228, v230
    v_add_f32 v227, v227, v229
    v_add_f32 v228, v228, v230
    v_mov_b32 v229, v227
    v_mov_b32 v230, v228
    s_nop 0
    v_permlane32_swap_b32 v227, v229
    v_permlane32_swap_b32 v228, v230
    v_add_f32 v227, v227, v229
    v_add_f32 v228, v228, v230
    v_rcp_f32 v227, v227
    s_sub_i32 s72, 0, s65
    v_mul_f32 v228, v228, v227
    v_ldexp_f32 v228, v228, s72
    v_cvt_pk_bf16_f32 v228, v228, v228
    v_lshrrev_b32 v229, 4, v0
    s_lshl_b32 s72, s2, 5
    s_lshl_b32 s73, s56, 2
    s_add_u32 s72, s72, s73
    s_mov_b64 exec, 0x101
    buffer_store_short v228, v229, s[48:51], s72 offen
L_end:
    s_endpgm
L_rare:
    s_mov_b32 s74, s66
L_rare_loop:
    s_min_u32 s72, s74, 14
    s_sub_u32 s74, s74, s72
    s_sub_u32 s72, 15, s72
    s_lshl_b32 s72, s72, 10
    s_mul_i32 s72, s72, 0x10001
    v_pk_mul_f16 v16, v16, s72
    v_pk_mul_f16 v17, v17, s72
    v_pk_mul_f16 v18, v18, s72
    v_pk_mul_f16 v19, v19, s72
    v_pk_mul_f16 v20, v20, s72
    v_pk_mul_f16 v21, v21, s72
    v_pk_mul_f16 v22, v22, s72
    v_pk_mul_f16 v23, v23, s72
    v_pk_mul_f16 v24, v24, s72
    v_pk_mul_f16 v25, v25, s72
    v_pk_mul_f16 v26, v26, s72
    v_pk_mul_f16 v27, v27, s72
    v_pk_mul_f16 v28, v28, s72
    v_pk_mul_f16 v29, v29, s72
    v_pk_mul_f16 v30, v30, s72
    v_pk_mul_f16 v31, v31, s72
    v_pk_mul_f16 v32, v32, s72
    v_pk_mul_f16 v33, v33, s72
    v_pk_mul_f16 v34, v34, s72
    v_pk_mul_f16 v35, v35, s72
    v_pk_mul_f16 v36, v36, s72
    v_pk_mul_f16 v37, v37, s72
    v_pk_mul_f16 v38, v38, s72
    v_pk_mul_f16 v39, v39, s72
    v_pk_mul_f16 v40, v40, s72
    v_pk_mul_f16 v41, v41, s72
    v_pk_mul_f16 v42, v42, s72
    v_pk_mul_f16 v43, v43, s72
    v_pk_mul_f16 v44, v44, s72
    v_pk_mul_f16 v45, v45, s72
    v_pk_mul_f16 v46, v46, s72
    v_pk_mul_f16 v47, v47, s72
    s_cmp_lg_u32 s74, 0
    s_cbranch_scc1 L_rare_loop
    s_nop 1
    s_branch L_rare_back
L_slowW:
    s_max_u32 s60, s60, 87
    s_min_u32 s60, s60, 245
    s_sub_i32 s39, s60, 119
    s_waitcnt lgkmcnt(0)
    s_barrier
    s_cmp_lt_u32 s56, 4
    s_cbranch_scc1 L_slowW2
    s_sub_u32 s72, 246, s60
    s_lshl_b32 s72, s72, 23
    v_lshrrev_b32 v8, 3, v5
    v_mul_u32_u24 v8, 288, v8
    v_and_b32 v9, 7, v5
    v_lshl_add_u32 v8, v9, 4, v8
    v_add_u32 v12, s94, v8
    v_lshlrev_b32 v8, 16, v144
    v_and_b32 v9, s38, v144
    v_mul_f32 v8, s72, v8
    v_mul_f32 v9, s72, v9
    v_cvt_pk_f16_f32 v144, v8, v9
    v_lshlrev_b32 v8, 16, v145
    v_and_b32 v9, s38, v145
    v_mul_f32 v8, s72, v8
    v_mul_f32 v9, s72, v9
    v_cvt_pk_f16_f32 v145, v8, v9
    v_lshlrev_b32 v8, 16, v146
    v_and_b32 v9, s38, v146
    v_mul_f32 v8, s72, v8
    v_mul_f32 v9, s72, v9
    v_cvt_pk_f16_f32 v146, v8, v9
    v_lshlrev_b32 v8, 16, v147
    v_and_b32 v9, s38, v147
    v_mul_f32 v8, s72, v8
    v_mul_f32 v9, s72, v9
    v_cvt_pk_f16_f32 v147, v8, v9
    v_lshlrev_b32 v8, 16, v148
    v_and_b32 v9, s38, v148
    v_mul_f32 v8, s72, v8
    v_mul_f32 v9, s72, v9
    v_cvt_pk_f16_f32 v148, v8, v9
    v_lshlrev_b32 v8, 16, v149
    v_and_b32 v9, s38, v149
    v_mul_f32 v8, s72, v8
    v_mul_f32 v9, s72, v9
    v_cvt_pk_f16_f32 v149, v8, v9
    v_lshlrev_b32 v8, 16, v150
    v_and_b32 v9, s38, v150
    v_mul_f32 v8, s72, v8
    v_mul_f32 v9, s72, v9
    v_cvt_pk_f16_f32 v150, v8, v9
    v_lshlrev_b32 v8, 16, v151
    v_and_b32 v9, s38, v151
    v_mul_f32 v8, s72, v8
    v_mul_f32 v9, s72, v9
    v_cvt_pk_f16_f32 v151, v8, v9
    ds_write_b128 v12, v[144:147]
    ds_write_b128 v12, v[148:151] offset:2304
L_slowW2:
    s_waitcnt lgkmcnt(0)
    s_barrier
    ds_read_b64_tr_b16 v[16:17], v3 offset:0
    ds_read_b64_tr_b16 v[18:19], v3 offset:1152
    ds_read_b64_tr_b16 v[20:21], v3 offset:2304
    ds_read_b64_tr_b16 v[22:23], v3 offset:3456
    ds_read_b64_tr_b16 v[24:25], v3 offset:32
    ds_read_b64_tr_b16 v[26:27], v3 offset:1184
    ds_read_b64_tr_b16 v[28:29], v3 offset:2336
    ds_read_b64_tr_b16 v[30:31], v3 offset:3488
    ds_read_b64_tr_b16 v[32:33], v3 offset:64
    ds_read_b64_tr_b16 v[34:35], v3 offset:1216
    ds_read_b64_tr_b16 v[36:37], v3 offset:2368
    ds_read_b64_tr_b16 v[38:39], v3 offset:3520
    ds_read_b64_tr_b16 v[40:41], v3 offset:96
    ds_read_b64_tr_b16 v[42:43], v3 offset:1248
    ds_read_b64_tr_b16 v[44:45], v3 offset:2400
    ds_read_b64_tr_b16 v[46:47], v3 offset:3552
    s_waitcnt lgkmcnt(0)
    s_branch L_slowW_back
L_slowE:
    s_waitcnt lgkmcnt(0)
    s_nop 15
    s_nop 15
    ds_bpermute_b32 v128, v232, v237 offset:0
    ds_bpermute_b32 v129, v232, v237 offset:32
    ds_bpermute_b32 v130, v232, v237 offset:64
    ds_bpermute_b32 v131, v232, v237 offset:96
    ds_bpermute_b32 v132, v232, v237 offset:128
    ds_bpermute_b32 v133, v232, v237 offset:160
    ds_bpermute_b32 v134, v232, v237 offset:192
    s_waitcnt lgkmcnt(6)
    v_lshl_add_u32 v128, v128, 7, v233
    buffer_load_dwordx4 v[196:199], v128, s[28:31], 0 offen
    s_waitcnt lgkmcnt(5)
    v_lshl_add_u32 v129, v129, 7, v233
    buffer_load_dwordx4 v[200:203], v129, s[28:31], 0 offen
    s_waitcnt lgkmcnt(4)
    v_lshl_add_u32 v130, v130, 7, v233
    buffer_load_dwordx4 v[212:215], v130, s[28:31], 0 offen
    s_waitcnt lgkmcnt(3)
    v_lshl_add_u32 v131, v131, 7, v233
    buffer_load_dwordx4 v[204:207], v131, s[28:31], 0 offen
    s_waitcnt lgkmcnt(2)
    v_lshl_add_u32 v132, v132, 7, v233
    buffer_load_dwordx4 v[208:211], v132, s[28:31], 0 offen
    s_waitcnt lgkmcnt(1)
    v_lshl_add_u32 v133, v133, 7, v233
    buffer_load_dwordx4 v[216:219], v133, s[28:31], 0 offen
    s_waitcnt lgkmcnt(0)
    v_lshl_add_u32 v134, v134, 7, v233
    buffer_load_dwordx4 v[220:223], v134, s[28:31], 0 offen
    s_waitcnt vmcnt(0)
    v_pk_maximum3_f16 v224, v196, v196, v196 neg_lo:[0,1,0] neg_hi:[0,1,0]
    v_pk_maximum3_f16 v224, v197, v197, v224 neg_lo:[0,1,0] neg_hi:[0,1,0]
    v_pk_maximum3_f16 v224, v198, v198, v224 neg_lo:[0,1,0] neg_hi:[0,1,0]
    v_pk_maximum3_f16 v224, v199, v199, v224 neg_lo:[0,1,0] neg_hi:[0,1,0]
    v_pk_maximum3_f16 v224, v200, v200, v224 neg_lo:[0,1,0] neg_hi:[0,1,0]
    v_pk_maximum3_f16 v224, v201, v201, v224 neg_lo:[0,1,0] neg_hi:[0,1,0]
    v_pk_maximum3_f16 v224, v202, v202, v224 neg_lo:[0,1,0] neg_hi:[0,1,0]
    v_pk_maximum3_f16 v224, v203, v203, v224 neg_lo:[0,1,0] neg_hi:[0,1,0]
    v_pk_maximum3_f16 v224, v212, v212, v224 neg_lo:[0,1,0] neg_hi:[0,1,0]
    v_pk_maximum3_f16 v224, v213, v213, v224 neg_lo:[0,1,0] neg_hi:[0,1,0]
    v_pk_maximum3_f16 v224, v214, v214, v224 neg_lo:[0,1,0] neg_hi:[0,1,0]
    v_pk_maximum3_f16 v224, v215, v215, v224 neg_lo:[0,1,0] neg_hi:[0,1,0]
    v_pk_maximum3_f16 v224, v204, v204, v224 neg_lo:[0,1,0] neg_hi:[0,1,0]
    v_pk_maximum3_f16 v224, v205, v205, v224 neg_lo:[0,1,0] neg_hi:[0,1,0]
    v_pk_maximum3_f16 v224, v206, v206, v224 neg_lo:[0,1,0] neg_hi:[0,1,0]
    v_pk_maximum3_f16 v224, v207, v207, v224 neg_lo:[0,1,0] neg_hi:[0,1,0]
    v_pk_maximum3_f16 v224, v208, v208, v224 neg_lo:[0,1,0] neg_hi:[0,1,0]
    v_pk_maximum3_f16 v224, v209, v209, v224 neg_lo:[0,1,0] neg_hi:[0,1,0]
    v_pk_maximum3_f16 v224, v210, v210, v224 neg_lo:[0,1,0] neg_hi:[0,1,0]
    v_pk_maximum3_f16 v224, v211, v211, v224 neg_lo:[0,1,0] neg_hi:[0,1,0]
    v_pk_maximum3_f16 v224, v216, v216, v224 neg_lo:[0,1,0] neg_hi:[0,1,0]
    v_pk_maximum3_f16 v224, v217, v217, v224 neg_lo:[0,1,0] neg_hi:[0,1,0]
    v_pk_maximum3_f16 v224, v218, v218, v224 neg_lo:[0,1,0] neg_hi:[0,1,0]
    v_pk_maximum3_f16 v224, v219, v219, v224 neg_lo:[0,1,0] neg_hi:[0,1,0]
    v_pk_maximum3_f16 v224, v220, v220, v224 neg_lo:[0,1,0] neg_hi:[0,1,0]
    v_pk_maximum3_f16 v224, v221, v221, v224 neg_lo:[0,1,0] neg_hi:[0,1,0]
    v_pk_maximum3_f16 v224, v222, v222, v224 neg_lo:[0,1,0] neg_hi:[0,1,0]
    v_pk_maximum3_f16 v224, v223, v223, v224 neg_lo:[0,1,0] neg_hi:[0,1,0]
    v_max_u32_sdwa v224, v224, v224 dst_sel:DWORD dst_unused:UNUSED_PAD src0_sel:WORD_0 src1_sel:WORD_1
    s_nop 1
    v_max_u32_dpp v224, v224, v224 row_ror:8 row_mask:0xf bank_mask:0xf
    s_nop 1
    v_max_u32_dpp v224, v224, v224 row_ror:4 row_mask:0xf bank_mask:0xf
    s_nop 1
    v_max_u32_dpp v224, v224, v224 row_ror:2 row_mask:0xf bank_mask:0xf
    s_nop 1
    v_max_u32_dpp v224, v224, v224 row_ror:1 row_mask:0xf bank_mask:0xf
    s_nop 0
    v_readlane_b32 s72, v224, 0
    v_readlane_b32 s73, v224, 16
    v_readlane_b32 s74, v224, 32
    v_readlane_b32 s75, v224, 48
    s_nop 1
    s_max_u32 s63, s72, s73
    s_max_u32 s63, s63, s74
    s_max_u32 s63, s63, s75
    s_lshr_b32 s63, s63, 7
    s_max_u32 s63, s63, 87
    s_min_u32 s63, s63, 247
    s_lshl_b32 s72, s63, 1
    s_sub_i32 s43, 371, s72
    s_sub_i32 s72, s63, 126
    s_sub_i32 s68, 0, s72
    s_lshl_b32 s46, s72, 1
    v_cmp_gt_u32 vcc, 16, v5
    s_mov_b32 s47, 1
    v_lshlrev_b32 v8, 16, v196
    v_and_b32 v9, s38, v196
    v_ldexp_f32 v8, v8, s68
    v_ldexp_f32 v9, v9, s68
    v_cvt_pk_bf16_f32 v196, v8, v9
    v_lshlrev_b32 v8, 16, v197
    v_and_b32 v9, s38, v197
    v_ldexp_f32 v8, v8, s68
    v_ldexp_f32 v9, v9, s68
    v_cvt_pk_bf16_f32 v197, v8, v9
    v_lshlrev_b32 v8, 16, v198
    v_and_b32 v9, s38, v198
    v_ldexp_f32 v8, v8, s68
    v_ldexp_f32 v9, v9, s68
    v_cvt_pk_bf16_f32 v198, v8, v9
    v_lshlrev_b32 v8, 16, v199
    v_and_b32 v9, s38, v199
    v_ldexp_f32 v8, v8, s68
    v_ldexp_f32 v9, v9, s68
    v_cvt_pk_bf16_f32 v199, v8, v9
    v_lshlrev_b32 v8, 16, v200
    v_and_b32 v9, s38, v200
    v_ldexp_f32 v8, v8, s68
    v_ldexp_f32 v9, v9, s68
    v_cvt_pk_bf16_f32 v200, v8, v9
    v_lshlrev_b32 v8, 16, v201
    v_and_b32 v9, s38, v201
    v_ldexp_f32 v8, v8, s68
    v_ldexp_f32 v9, v9, s68
    v_cvt_pk_bf16_f32 v201, v8, v9
    v_lshlrev_b32 v8, 16, v202
    v_and_b32 v9, s38, v202
    v_ldexp_f32 v8, v8, s68
    v_ldexp_f32 v9, v9, s68
    v_cvt_pk_bf16_f32 v202, v8, v9
    v_lshlrev_b32 v8, 16, v203
    v_and_b32 v9, s38, v203
    v_ldexp_f32 v8, v8, s68
    v_ldexp_f32 v9, v9, s68
    v_cvt_pk_bf16_f32 v203, v8, v9
    v_lshlrev_b32 v8, 16, v212
    v_and_b32 v9, s38, v212
    v_ldexp_f32 v8, v8, s68
    v_ldexp_f32 v9, v9, s68
    v_cvt_pk_bf16_f32 v212, v8, v9
    v_lshlrev_b32 v8, 16, v213
    v_and_b32 v9, s38, v213
    v_ldexp_f32 v8, v8, s68
    v_ldexp_f32 v9, v9, s68
    v_cvt_pk_bf16_f32 v213, v8, v9
    v_lshlrev_b32 v8, 16, v214
    v_and_b32 v9, s38, v214
    v_ldexp_f32 v8, v8, s68
    v_ldexp_f32 v9, v9, s68
    v_cvt_pk_bf16_f32 v214, v8, v9
    v_lshlrev_b32 v8, 16, v215
    v_and_b32 v9, s38, v215
    v_ldexp_f32 v8, v8, s68
    v_ldexp_f32 v9, v9, s68
    v_cvt_pk_bf16_f32 v215, v8, v9
    v_lshlrev_b32 v8, 16, v204
    v_and_b32 v9, s38, v204
    v_ldexp_f32 v8, v8, s68
    v_ldexp_f32 v9, v9, s68
    v_cvt_pk_bf16_f32 v204, v8, v9
    v_lshlrev_b32 v8, 16, v205
    v_and_b32 v9, s38, v205
    v_ldexp_f32 v8, v8, s68
    v_ldexp_f32 v9, v9, s68
    v_cvt_pk_bf16_f32 v205, v8, v9
    v_lshlrev_b32 v8, 16, v206
    v_and_b32 v9, s38, v206
    v_ldexp_f32 v8, v8, s68
    v_ldexp_f32 v9, v9, s68
    v_cvt_pk_bf16_f32 v206, v8, v9
    v_lshlrev_b32 v8, 16, v207
    v_and_b32 v9, s38, v207
    v_ldexp_f32 v8, v8, s68
    v_ldexp_f32 v9, v9, s68
    v_cvt_pk_bf16_f32 v207, v8, v9
    v_lshlrev_b32 v8, 16, v208
    v_and_b32 v9, s38, v208
    v_ldexp_f32 v8, v8, s68
    v_ldexp_f32 v9, v9, s68
    v_cvt_pk_bf16_f32 v208, v8, v9
    v_lshlrev_b32 v8, 16, v209
    v_and_b32 v9, s38, v209
    v_ldexp_f32 v8, v8, s68
    v_ldexp_f32 v9, v9, s68
    v_cvt_pk_bf16_f32 v209, v8, v9
    v_lshlrev_b32 v8, 16, v210
    v_and_b32 v9, s38, v210
    v_ldexp_f32 v8, v8, s68
    v_ldexp_f32 v9, v9, s68
    v_cvt_pk_bf16_f32 v210, v8, v9
    v_lshlrev_b32 v8, 16, v211
    v_and_b32 v9, s38, v211
    v_ldexp_f32 v8, v8, s68
    v_ldexp_f32 v9, v9, s68
    v_cvt_pk_bf16_f32 v211, v8, v9
    v_lshlrev_b32 v8, 16, v216
    v_and_b32 v9, s38, v216
    v_ldexp_f32 v8, v8, s68
    v_ldexp_f32 v9, v9, s68
    v_cvt_pk_bf16_f32 v216, v8, v9
    v_lshlrev_b32 v8, 16, v217
    v_and_b32 v9, s38, v217
    v_ldexp_f32 v8, v8, s68
    v_ldexp_f32 v9, v9, s68
    v_cvt_pk_bf16_f32 v217, v8, v9
    v_lshlrev_b32 v8, 16, v218
    v_and_b32 v9, s38, v218
    v_ldexp_f32 v8, v8, s68
    v_ldexp_f32 v9, v9, s68
    v_cvt_pk_bf16_f32 v218, v8, v9
    v_lshlrev_b32 v8, 16, v219
    v_and_b32 v9, s38, v219
    v_ldexp_f32 v8, v8, s68
    v_ldexp_f32 v9, v9, s68
    v_cvt_pk_bf16_f32 v219, v8, v9
    v_lshlrev_b32 v8, 16, v220
    v_and_b32 v9, s38, v220
    v_ldexp_f32 v8, v8, s68
    v_ldexp_f32 v9, v9, s68
    v_cvt_pk_bf16_f32 v220, v8, v9
    v_lshlrev_b32 v8, 16, v221
    v_and_b32 v9, s38, v221
    v_ldexp_f32 v8, v8, s68
    v_ldexp_f32 v9, v9, s68
    v_cvt_pk_bf16_f32 v221, v8, v9
    v_lshlrev_b32 v8, 16, v222
    v_and_b32 v9, s38, v222
    v_ldexp_f32 v8, v8, s68
    v_ldexp_f32 v9, v9, s68
    v_cvt_pk_bf16_f32 v222, v8, v9
    v_lshlrev_b32 v8, 16, v223
    v_and_b32 v9, s38, v223
    v_ldexp_f32 v8, v8, s68
    v_ldexp_f32 v9, v9, s68
    v_cvt_pk_bf16_f32 v223, v8, v9
    v_mov_b32 v65, 0
    v_mov_b64 v[66:67], 0
    v_mov_b32 v69, 0
    v_mov_b64 v[70:71], 0
    v_mov_b32 v73, 0
    v_mov_b64 v[74:75], 0
    v_mov_b32 v77, 0
    v_mov_b64 v[78:79], 0
    v_mov_b32 v81, 0
    v_mov_b64 v[82:83], 0
    ds_read_u16 v64, v6 offset:0
    ds_read_u16 v68, v6 offset:32
    ds_read_u16 v72, v6 offset:64
    ds_read_u16 v76, v6 offset:96
    ds_read_b64_tr_b16 v[16:17], v3 offset:0
    ds_read_b64_tr_b16 v[18:19], v3 offset:1152
    ds_read_b64_tr_b16 v[20:21], v3 offset:2304
    ds_read_b64_tr_b16 v[22:23], v3 offset:3456
    ds_read_b64_tr_b16 v[24:25], v3 offset:32
    ds_read_b64_tr_b16 v[26:27], v3 offset:1184
    ds_read_b64_tr_b16 v[28:29], v3 offset:2336
    ds_read_b64_tr_b16 v[30:31], v3 offset:3488
    ds_read_b64_tr_b16 v[32:33], v3 offset:64
    ds_read_b64_tr_b16 v[34:35], v3 offset:1216
    ds_read_b64_tr_b16 v[36:37], v3 offset:2368
    ds_read_b64_tr_b16 v[38:39], v3 offset:3520
    ds_read_b64_tr_b16 v[40:41], v3 offset:96
    ds_read_b64_tr_b16 v[42:43], v3 offset:1248
    ds_read_b64_tr_b16 v[44:45], v3 offset:2400
    ds_read_b64_tr_b16 v[46:47], v3 offset:3552
    s_waitcnt lgkmcnt(0)
    s_branch L_rebook

.p2align 6
L_tab:
    .long 0x13200d80, 0x0d800e10, 0x05100d80, 0x0d800e10, 0x0e100d80, 0x0d8005a0, 0x06300d80, 0x0d800e10
    .long 0x0e100d80, 0x0d800d80, 0x0c600d80, 0x0d800510, 0x13200e10, 0x0d800bd0, 0x05a00d80, 0x0d800cf0
    .long 0x24902d00, 0x2d002d90, 0x2c702d00, 0x2d002520, 0x24902d90, 0x2d002be0, 0x2b502d00, 0x2d0032a0
    .long 0x25b02d00, 0x2d002d90, 0x2d902d00, 0x2d002520, 0x2d002d00, 0x2d002d90, 0x32a02d00, 0x2d002d90
    .long 0x13400da0, 0x0da00e30, 0x05300da0, 0x0da00e30, 0x0e300da0, 0x0da005c0, 0x06500da0, 0x0da00e30
    .long 0x0e300da0, 0x0da00da0, 0x0c800da0, 0x0da00530, 0x13400e30, 0x0da00bf0, 0x05c00da0, 0x0da00d10
    .long 0x24b02d20, 0x2d202db0, 0x2c902d20, 0x2d202540, 0x24b02db0, 0x2d202c00, 0x2b702d20, 0x2d2032c0
    .long 0x25d02d20, 0x2d202db0, 0x2db02d20, 0x2d202540, 0x2d202d20, 0x2d202db0, 0x32c02d20, 0x2d202db0
    .long 0x13600dc0, 0x0dc00e50, 0x05500dc0, 0x0dc00e50, 0x0e500dc0, 0x0dc005e0, 0x06700dc0, 0x0dc00e50
    .long 0x0e500dc0, 0x0dc00dc0, 0x0ca00dc0, 0x0dc00550, 0x13600e50, 0x0dc00c10, 0x05e00dc0, 0x0dc00d30
    .long 0x24d02d40, 0x2d402dd0, 0x2cb02d40, 0x2d402560, 0x24d02dd0, 0x2d402c20, 0x2b902d40, 0x2d4032e0
    .long 0x25f02d40, 0x2d402dd0, 0x2dd02d40, 0x2d402560, 0x2d402d40, 0x2d402dd0, 0x32e02d40, 0x2d402dd0
    .long 0x13800de0, 0x0de00e70, 0x05700de0, 0x0de00e70, 0x0e700de0, 0x0de00600, 0x06900de0, 0x0de00e70
    .long 0x0e700de0, 0x0de00de0, 0x0cc00de0, 0x0de00570, 0x13800e70, 0x0de00c30, 0x06000de0, 0x0de00d50
    .long 0x24f02d60, 0x2d602df0, 0x2cd02d60, 0x2d602580, 0x24f02df0, 0x2d602c40, 0x2bb02d60, 0x2d603300
    .long 0x26102d60, 0x2d602df0, 0x2df02d60, 0x2d602580, 0x2d602d60, 0x2d602df0, 0x33002d60, 0x2d602df0
L_alldone:
.section .rodata,"a"
.p2align 6
.amdhsa_kernel standalone__factorization_afm__recsys_kernel
  .amdhsa_next_free_vgpr 248
  .amdhsa_next_free_sgpr 102
  .amdhsa_accum_offset 248
  .amdhsa_group_segment_fixed_size 0
  .amdhsa_kernarg_size 88
  .amdhsa_user_sgpr_count 2
  .amdhsa_user_sgpr_kernarg_segment_ptr 1
  .amdhsa_system_sgpr_workgroup_id_x 1
  .amdhsa_float_denorm_mode_32 3
.end_amdhsa_kernel
```
